```python
import torch

def _softmax(x, axis=-1):
    return torch.softmax(x, dim=axis)
def _gelu(x):
    return torch.nn.functional.gelu(x, approximate="tanh")
def _silu(x):
    return torch.nn.functional.silu(x)
def _sigmoid(x):
    return torch.sigmoid(x)
def _layernorm(x, axis=-1, eps=1e-5):
    m = x.mean(dim=axis, keepdim=True)
    v = x.var(dim=axis, keepdim=True, unbiased=False)
    return (x - m) / torch.sqrt(v + eps)
def _scatter_add(tgt, idx, src, axis=0):
    return tgt.clone().index_add_(axis, idx, src)
def _segment_sum(src, seg, n):
    out = torch.zeros((n,) + src.shape[1:], dtype=src.dtype)
    return out.index_add_(0, seg, src)
def _pad(x, pw):
    flat = tuple(v for pair in reversed(pw) for v in pair)
    return torch.nn.functional.pad(x, flat)

kernel_name = 'gated_mix__sliding_local_dilated__softmax_full_mha__prompt'

def setup_inputs():

    _w = (lambda a: (lambda t: t.to(torch.bfloat16) if t.is_floating_point() else t)(torch.as_tensor(a)))
    def _A_setup():
        B, S, D = 1, 2048, 512
        return {
            "x": _w((lambda *s: torch.randn(*s, dtype=torch.bfloat16) * 0.05)(B, S, D)),
            "wqkv": _w((lambda *s: torch.randn(*s, dtype=torch.bfloat16) * 1.6)(D, 3 * D)),
            "wo": _w((lambda *s: torch.randn(*s, dtype=torch.bfloat16) * 0.05)(D, D)),
        }
    _A_in = _A_setup()

    def _B_setup():
        B, S, D = 1, 2048, 512
        return {
            "x": _w((lambda *s: torch.randn(*s, dtype=torch.bfloat16) * 0.05)(B, S, D)),
            "wqkv": _w((lambda *s: torch.randn(*s, dtype=torch.bfloat16) * 1.6)(D, 3 * D)),
            "wo": _w((lambda *s: torch.randn(*s, dtype=torch.bfloat16) * 0.1)(D, D)),
        }
    _B_in = _B_setup()

    return {
        "A_x": _A_in["x"],
        "A_wqkv": _A_in["wqkv"],
        "A_wo": _A_in["wo"],
        "B_x": _B_in["x"],
        "B_wqkv": _B_in["wqkv"],
        "B_wo": _B_in["wo"],
        "gate_w": _w((lambda *s: torch.randn(*s, dtype=torch.bfloat16) * 0.05)(512) * 16.0),
    }

def reference(A_x, A_wqkv, A_wo, B_x, B_wqkv, B_wo, gate_w):
    def _A_ref(x, wqkv, wo):
        B, S, D = x.shape
        H = 32; Dh = D // H
        W, dil = 8, 2
        qkv = (lambda x, *d: x.permute(*d))((x @ wqkv).reshape(B, S, 3, H, Dh), 2, 0, 3, 1, 4)
        q, k, v = qkv[0], qkv[1], qkv[2]
        scale = Dh ** -0.5
        pos = torch.arange(S)
        off = torch.arange(W) * dil
        idx = pos[:, None] - off[None, :]
        mask = idx >= 0
        idx_c = torch.where(mask, idx, 0).reshape(-1)
        kg = k[:, :, idx_c, :].reshape(B, H, S, W, Dh)
        vg = v[:, :, idx_c, :].reshape(B, H, S, W, Dh)
        logits = torch.einsum("bhsd,bhswd->bhsw", q, kg) * scale
        logits = torch.where(mask[None, None, :, :], logits, -1e9)
        attn = _softmax(logits, axis=-1)
        o = torch.einsum("bhsw,bhswd->bhsd", attn, vg)
        return (lambda x, *d: x.permute(*d))(o, 0, 2, 1, 3).reshape(B, S, D) @ wo

    def _B_ref(x, wqkv, wo):
        B, S, D = x.shape
        H = 32; Dh = D // H
        qkv = (lambda x, *d: x.permute(*d))((x @ wqkv).reshape(B, S, 3, H, Dh), 2, 0, 3, 1, 4)
        q, k, v = qkv[0], qkv[1], qkv[2]
        scale = Dh ** -0.5
        scores = torch.einsum("bhqd,bhkd->bhqk", q, k) * scale
        p = _softmax(scores, axis=-1)
        o = torch.einsum("bhqk,bhkd->bhqd", p, v)
        return (lambda x, *d: x.permute(*d))(o, 0, 2, 1, 3).reshape(B, S, D) @ wo

    x = A_x
    g = _sigmoid((x * gate_w).sum(-1, keepdims=True))
    a = _A_ref(x, A_wqkv, A_wo)
    b = _B_ref(x, B_wqkv, B_wo)
    return g * a + (1 - g) * b
```

```asm
; @launch grid=(256,1,1) block=(512,1,1) lds=163840
.amdgcn_target "amdgcn-amd-amdhsa--gfx950"
.text
.globl gated_mix__sliding_local_dilated__softmax_full_mha__prompt_kernel
.p2align 8
.type gated_mix__sliding_local_dilated__softmax_full_mha__prompt_kernel,@function
gated_mix__sliding_local_dilated__softmax_full_mha__prompt_kernel:
    s_cmp_ge_u32 s2, 256
    s_cbranch_scc1 L_end
    s_load_dwordx4 s[4:7], s[0:1], 0
    s_load_dwordx4 s[12:15], s[0:1], 32
    s_load_dwordx4 s[20:23], s[0:1], 64
    s_load_dwordx2 s[8:9], s[0:1], 16
    s_load_dwordx4 s[16:19], s[0:1], 48
    s_getpc_b64 s[96:97]
L_pc:
    v_cmp_gt_u32 vcc, (L_code_end - L_pc) / 4096, v0
    s_lshr_b32 s3, s2, 3
    s_lshl_b32 s3, s3, 7
    s_and_saveexec_b64 s[98:99], vcc
    s_cbranch_execz L_nopf
    v_lshlrev_b32 v2, 12, v0
    v_add_u32 v2, s3, v2
    global_load_dword v144, v2, s[96:97]
L_nopf:
    s_mov_b64 exec, -1
    v_and_b32 v1, 63, v0
    v_lshrrev_b32 v2, 6, v0
    s_and_b32 s29, s2, 7
    v_readfirstlane_b32 s28, v2
    s_lshr_b32 s30, s2, 3
    s_and_b32 s62, s29, 1
    s_lshr_b32 s31, s29, 1
    s_xor_b32 s31, s31, 0
    s_and_b32 s10, s30, 1
    s_lshr_b32 s11, s30, 1
    s_lshl_b32 s60, s31, 1
    s_add_u32 s60, s60, s10
    s_lshl_b32 s61, s62, 4
    s_add_u32 s61, s61, s11
    s_lshl_b32 s63, s10, 2
    s_add_u32 s63, s63, s11
    s_and_b32 s63, s63, 7
    s_lshl_b32 s63, s63, 7
    s_lshl_b32 s26, s62, 2
    s_add_u32 s26, s26, s31
    s_lshl_b32 s26, s26, 3
    s_lshr_b32 s3, s30, 2
    s_add_u32 s26, s26, s3
    s_and_b32 s27, s30, 3
    s_lshl_b32 s24, s31, 3
    s_and_b32 s3, s30, 7
    s_add_u32 s24, s24, s3
    s_lshl_b32 s25, s62, 2
    s_lshr_b32 s3, s30, 3
    s_add_u32 s25, s25, s3
    s_lshl_b32 s64, s28, 10
    s_mul_i32 s100, s28, 3072
    v_lshlrev_b32 v4, 4, v1
    v_lshlrev_b32 v5, 2, v1
    v_lshrrev_b32 v2, 3, v1
    s_lshl_b32 s3, s61, 3
    s_add_u32 s3, s3, s28
    s_lshl_b32 s3, s3, 3
    v_add_u32 v3, s3, v2
    v_lshlrev_b32 v3, 10, v3
    v_lshrrev_b32 v0, 4, v1
    v_xor_b32 v0, v0, v1
    s_and_b32 s3, s28, 1
    s_lshl_b32 s3, s3, 2
    v_xor_b32 v0, s3, v0
    v_and_b32 v0, 7, v0
    v_lshl_add_u32 v6, v0, 4, v3
    s_lshl_b32 s3, s28, 3
    v_add_u32 v2, s3, v2
    v_mul_u32_u24 v2, 3072, v2
    v_and_b32 v3, 7, v1
    v_lshlrev_b32 v3, 4, v3
    v_bfe_u32 v0, v1, 4, 1
    v_lshlrev_b32 v0, 6, v0
    v_xor_b32 v3, v3, v0
    s_lshl_b32 s3, s60, 7
    s_and_b32 s11, s28, 1
    s_lshl_b32 s11, s11, 5
    v_xor_b32 v3, s11, v3
    v_add3_u32 v7, v2, v3, s3
    s_lshl_b32 s3, s30, 3
    s_add_u32 s3, s3, s28
    s_lshl_b32 s3, s3, 13
    s_lshl_b32 s11, s31, 8
    s_add_u32 s3, s3, s11
    v_and_b32 v3, 7, v1
    v_lshlrev_b32 v3, 10, v3
    v_bfe_u32 v0, v1, 3, 1
    v_lshl_add_u32 v3, v0, 7, v3
    v_add_u32 v156, s3, v3
    s_cmp_ge_u32 s2, 128
    s_waitcnt lgkmcnt(0)
    s_cselect_b32 s56, s14, s8
    s_cselect_b32 s57, s15, s9
    s_mov_b32 s58, 524288
    s_mov_b32 s59, 0x00020000
    s_mov_b32 s32, s4
    s_mov_b32 s33, s5
    s_mov_b32 s34, 2097152
    s_mov_b32 s35, 0x00020000
    s_mov_b32 s36, s12
    s_mov_b32 s37, s13
    s_mov_b32 s38, 1572864
    s_mov_b32 s39, 0x00020000
    s_mov_b32 s44, s22
    s_mov_b32 s45, s23
    s_mov_b32 s46, 29360128
    s_mov_b32 s47, 0x00020000
    s_add_u32 m0, s64, 0
    s_xor_b32 s10, s63, 0
    buffer_load_dwordx4 v6, s[32:35], s10 offen lds
    s_add_u32 m0, s100, 65536
    s_mul_i32 s11, s10, 1536
    buffer_load_dwordx4 v7, s[36:39], s11 offen lds
    buffer_load_dwordx4 v7, s[36:39], s11 offen offset:1024 lds
    buffer_load_dwordx4 v7, s[36:39], s11 offen offset:2048 lds
    s_mov_b32 s12, 65536
    s_cmp_ge_u32 s2, 8
    s_cbranch_scc1 L_noclr
    s_lshl_b32 s3, s2, 3
    s_add_u32 s3, s3, s28
    s_lshl_b32 s3, s3, 10
    s_add_u32 s3, s3, 17825792
    v_mov_b32 v24, 0
    v_mov_b32 v25, 0
    v_mov_b32 v26, 0
    v_mov_b32 v27, 0
    s_mov_b32 exec_lo, 0x00ffffff
    buffer_store_dwordx4 v[24:27], v4, s[44:47], s3 offen sc1
    s_mov_b32 exec_lo, -1
L_noclr:
    v_and_b32 v5, 0x7c, v5
    v_lshrrev_b32 v2, 4, v1
    v_and_b32 v3, 15, v1
    s_lshr_b32 s3, s28, 2
    s_lshl_b32 s10, s61, 1
    s_add_u32 s72, s10, s3
    s_lshl_b32 s3, s3, 12
    v_lshlrev_b32 v3, 7, v3
    v_add_u32 v3, s3, v3
    v_bfe_u32 v0, v1, 1, 3
    v_xor_b32 v0, v0, v2
    v_lshl_add_u32 v9, v0, 4, v3
    v_xor_b32 v10, 64, v9
    s_and_b32 s3, s28, 3
    s_lshl_b32 s10, s60, 2
    s_add_u32 s73, s10, s3
    s_lshl_b32 s3, s3, 5
    v_mul_u32_u24 v3, 3072, v2
    v_bfe_u32 v0, v1, 2, 2
    v_lshl_add_u32 v3, v0, 7, v3
    v_and_b32 v0, 3, v1
    v_lshl_add_u32 v3, v0, 3, v3
    v_bfe_u32 v0, v1, 3, 1
    v_lshlrev_b32 v0, 6, v0
    v_xor_b32 v0, s3, v0
    v_bfe_u32 v18, v1, 4, 1
    v_lshlrev_b32 v19, 5, v18
    v_xor_b32 v0, v0, v19
    v_add3_u32 v13, v3, v0, s12
    v_add_u32 v14, 49152, v13
    s_mov_b32 s48, s20
    s_mov_b32 s49, s21
    s_mov_b32 s50, 256
    s_mov_b32 s51, 0x00020000
    s_mov_b32 s66, 555159045
    s_mov_b32 s67, 87831338
    s_mov_b32 s40, s6
    s_mov_b32 s41, s7
    s_barrier
    s_and_b32 s4, s2, 31
    s_lshl_b32 s20, s4, 14
    s_bfe_u32 s7, s2, 0x20005
    s_lshl_b32 s7, s7, 8
    s_add_u32 s20, s20, s7
    s_and_b32 s8, s28, 3
    s_lshl_b32 s7, s8, 6
    s_add_u32 s20, s20, s7
    s_lshr_b32 s7, s28, 2
    s_lshl_b32 s7, s7, 12
    s_add_u32 s20, s20, s7
    v_and_b32 v166, 31, v1
    v_lshrrev_b32 v167, 5, v1
    v_lshlrev_b32 v169, 13, v167
    v_lshl_add_u32 v169, v166, 1, v169
    v_lshlrev_b32 v167, 3, v167
    v_lshl_add_u32 v166, v166, 4, v167
    s_lshr_b32 s7, s7, 3
    v_add_u32 v166, s7, v166
    s_lshr_b32 s21, s2, 5
    buffer_load_ushort v152, v169, s[56:59], s20 offen offset:0
    buffer_load_ushort v153, v169, s[56:59], s20 offen offset:1024
    buffer_load_ushort v154, v169, s[56:59], s20 offen offset:2048
    buffer_load_ushort v155, v169, s[56:59], s20 offen offset:3072
    s_lshl_b32 s21, s21, 2
    s_add_u32 s21, s21, s8
    s_lshl_b32 s21, s21, 5
    s_add_u32 s21, s21, s4
    s_lshl_b32 s21, s21, 11
    s_add_u32 s21, s21, 18874368
    s_bfe_u32 s4, s2, 0x10004
    s_lshl_b32 s4, s4, 2
    s_add_u32 s8, s8, s4
    s_lshl_b32 s4, s8, 3
    s_lshr_b64 s[6:7], s[66:67], s4
    s_and_b32 s6, s6, 0xff
    s_lshl_b32 s4, s6, 7
    v_add_u32 v165, s4, v166
    v_lshrrev_b32 v165, 10, v165
    v_lshl_add_u32 v165, v165, 7, v166
    s_mov_b32 s42, 1572864
    s_mov_b32 s43, 0x00020000
    s_mov_b32 s52, s18
    s_mov_b32 s53, s19
    s_add_u32 m0, s64, 8192
    s_xor_b32 s10, s63, 128
    buffer_load_dwordx4 v6, s[32:35], s10 offen lds
    s_mov_b32 s54, 2097152
    s_mov_b32 s55, 0x00020000
    v_lshrrev_b32 v166, 3, v1
    v_lshlrev_b32 v166, 7, v166
    v_xor_b32 v166, s63, v166
    v_and_b32 v167, 7, v1
    v_lshl_add_u32 v145, v167, 4, v166
    s_lshl_b32 s4, s28, 3
    s_lshr_b64 s[6:7], s[66:67], s4
    s_and_b32 s6, s6, 0xff
    s_lshl_b32 s4, s6, 7
    v_add_u32 v158, s4, v4
    v_lshrrev_b32 v158, 10, v158
    v_lshl_add_u32 v158, v158, 7, v4
    s_lshl_b32 s5, s25, 3
    s_add_u32 s5, s5, s28
    s_lshl_b32 s5, s5, 6
    s_and_b32 s4, s24, 24
    s_add_u32 s5, s5, s4
    s_and_b32 s4, s24, 1
    s_lshl_b32 s4, s4, 2
    s_add_u32 s5, s5, s4
    s_bfe_u32 s4, s24, 0x20001
    s_add_u32 s5, s5, s4
    s_lshr_b32 s4, s5, 6
    s_add_u32 m0, s100, 90112
    s_mul_i32 s11, s10, 1536
    buffer_load_dwordx4 v7, s[36:39], s11 offen lds
    s_lshl_b32 s101, s4, 13
    s_and_b32 s4, s5, 31
    s_lshl_b32 s4, s4, 8
    s_add_u32 s101, s101, s4
    s_add_u32 s101, s101, 17956864
    s_lshl_b32 s4, s26, 3
    s_add_u32 s4, s4, s28
    s_lshl_b32 s4, s4, 10
    s_add_u32 s95, s4, 17956864
    s_lshl_b32 s5, s5, 11
    s_add_u32 s90, s5, 21037056
    v_mov_b32 v160, -1
    v_mov_b32 v161, -1
    v_mov_b32 v162, -1
    v_mov_b32 v163, -1
    s_and_b32 s8, s72, 7
    s_lshl_b32 s93, s8, 3
    s_lshr_b64 s[6:7], s[66:67], s93
    s_and_b32 s6, s6, 0xff
    s_lshl_b32 s93, s6, 7
    v_add_u32 v159, s93, v4
    v_lshrrev_b32 v159, 10, v159
    v_lshl_add_u32 v159, v159, 7, v4
    s_and_b32 s8, s28, 3
    s_lshl_b32 s4, s8, 3
    buffer_load_dwordx4 v7, s[36:39], s11 offen offset:1024 lds
    s_lshr_b64 s[6:7], s[66:67], s4
    s_and_b32 s6, s6, 0xff
    s_lshl_b32 s4, s6, 7
    v_add_u32 v164, s4, v4
    v_lshrrev_b32 v164, 10, v164
    v_lshl_add_u32 v164, v164, 7, v4
    s_and_b32 s8, s26, 7
    s_lshl_b32 s94, s8, 3
    s_lshr_b64 s[6:7], s[66:67], s94
    s_and_b32 s6, s6, 0xff
    s_lshl_b32 s94, s6, 7
    s_lshl_b32 s76, s24, 9
    s_add_u32 s76, s76, 17825792
    s_lshl_b32 s77, s26, 8
    s_add_u32 s77, s77, 17842176
    s_lshl_b32 s83, s60, 5
    s_add_u32 s83, s83, s61
    s_lshr_b32 s4, s83, 2
    s_lshl_b32 s4, s4, 8
    s_add_u32 s78, s4, 17858560
    s_and_b32 s4, s83, 3
    s_lshl_b32 s4, s4, 3
    s_add_u32 s96, s4, s28
    s_add_u32 s6, s83, 1
    s_lshr_b32 s4, s6, 2
    buffer_load_dwordx4 v7, s[36:39], s11 offen offset:2048 lds
    s_lshl_b32 s4, s4, 7
    s_lshl_b32 s97, s6, 5
    s_add_u32 s97, s97, s4
    s_add_u32 s97, s97, 17858560
    s_cmp_lt_u32 s28, 4
    s_cselect_b32 s74, 1, 0
    s_cselect_b32 s75, 0, 1
    s_cmp_eq_u32 s61, 0
    s_cselect_b32 s74, 0, s74
    s_cmp_eq_u32 s61, 31
    s_cselect_b32 s75, 0, s75
    s_mov_b32 s70, 0xffff0000
    s_mov_b32 s71, 0xffff0000
    s_lshl_b32 s4, s62, 4
    s_lshl_b32 s68, 0xffff, s4
    s_not_b32 s88, s68
    s_mov_b32 s69, 0
    v_lshlrev_b32 v149, 9, v1
    s_lshl_b32 s99, s60, 11
    s_lshl_b32 s4, s61, 2
    s_add_u32 s99, s99, s4
    s_add_u32 s99, s99, 17825792
    s_lshl_b32 s81, s24, 6
    s_add_u32 s81, s81, s28
    s_lshl_b32 s81, s81, 11
    s_lshl_b32 s4, s62, 16
    s_add_u32 s79, s81, s4
    s_xor_b32 s4, s4, 65536
    s_add_u32 s80, s81, s4
    s_lshl_b32 s4, s25, 14
    s_add_u32 s81, s81, s4
    s_mov_b32 s82, 0
    v_lshrrev_b32 v136, 5, v1
    v_and_b32 v137, 15, v1
    v_lshlrev_b32 v137, 4, v137
    v_lshl_add_u32 v137, v136, 9, v137
    v_add_u32 v137, 65536, v137
    v_add_u32 v138, 256, v137
    v_mov_b32 v151, 66560
    s_lshr_b32 s5, s28, 2
    v_cndmask_b32 v150, v137, v151, s[70:71]
    v_cndmask_b32 v151, v138, v151, s[70:71]
    s_lshl_b32 s87, s27, 2
    s_and_b32 s9, s28, 3
    s_add_u32 s87, s87, s9
    s_lshl_b32 s87, s87, 1
    s_add_u32 s87, s87, s5
    s_lshl_b32 s87, s87, 15
    s_add_u32 s87, s87, 18874368
    s_waitcnt vmcnt(8)
    s_barrier
    ds_read_b128 v[80:83], v9 offset:0
    ds_read_b64_tr_b16 v[88:89], v13 offset:0
    ds_read_b64_tr_b16 v[90:91], v13 offset:512
    ds_read_b128 v[84:87], v9 offset:2048
    ds_read_b64_tr_b16 v[92:93], v13 offset:1024
    ds_read_b64_tr_b16 v[94:95], v13 offset:1536
    ds_read_b64_tr_b16 v[96:97], v13 offset:2048
    ds_read_b64_tr_b16 v[98:99], v13 offset:2560
    s_waitcnt lgkmcnt(5)
    v_mfma_f32_16x16x32_bf16 v[24:27], v[88:91], v[80:83], 0
    ds_read_b128 v[100:103], v10 offset:0
    ds_read_b64_tr_b16 v[108:109], v13 offset:12288
    s_waitcnt lgkmcnt(6)
    v_mfma_f32_16x16x32_bf16 v[28:31], v[88:91], v[84:87], 0
    ds_read_b64_tr_b16 v[110:111], v13 offset:12800
    s_add_u32 m0, s64, 16384
    s_xor_b32 s10, s63, 256
    buffer_load_dwordx4 v6, s[32:35], s10 offen lds
    s_lshl_b32 s86, s26, 2
    s_add_u32 s86, s86, s5
    s_lshl_b32 s86, s86, 15
    s_add_u32 s86, s86, 20971520
    s_mul_i32 s9, s5, 73856
    s_add_u32 s9, s9, 0
    v_add_u32 v18, s9, v4
    s_mul_i32 s9, s5, 115712
    s_waitcnt lgkmcnt(5)
    v_mfma_f32_16x16x32_bf16 v[32:35], v[92:95], v[80:83], 0
    ds_read_b128 v[104:107], v10 offset:2048
    s_add_u32 s92, s9, 16384
    v_add_u32 v157, s92, v4
    s_and_b32 s9, s28, 3
    s_lshl_b32 s9, s9, 12
    s_add_u32 s92, s92, s9
    s_lshl_b32 s9, s9, 1
    s_add_u32 s86, s86, s9
    v_lshl_add_u32 v22, v136, 10, v5
    v_mfma_f32_16x16x32_bf16 v[36:39], v[92:95], v[84:87], 0
    ds_read_b64_tr_b16 v[112:113], v13 offset:13312
    ds_read_b64_tr_b16 v[114:115], v13 offset:13824
    s_add_u32 m0, s100, 114688
    s_xor_b32 s10, s63, 256
    s_mul_i32 s11, s10, 1536
    buffer_load_dwordx4 v7, s[36:39], s11 offen lds
    s_waitcnt lgkmcnt(6)
    v_mfma_f32_16x16x32_bf16 v[40:43], v[80:83], v[96:99], 0
    ds_read_b64_tr_b16 v[116:117], v13 offset:14336
    v_and_b32 v137, 31, v1
    v_mul_u32_u24 v137, 528, v137
    v_lshl_add_u32 v137, v136, 4, v137
    s_mul_i32 s9, s5, 16896
    s_and_b32 s5, s28, 3
    s_lshl_b32 s5, s5, 7
    s_add_u32 s5, s5, s9
    s_add_u32 s5, s5, 90496
    v_mfma_f32_16x16x32_bf16 v[44:47], v[84:87], v[96:99], 0
    ds_read_b64_tr_b16 v[118:119], v13 offset:14848
    buffer_load_dwordx4 v7, s[36:39], s11 offen offset:1024 lds
    v_add_u32 v19, s5, v137
    v_lshrrev_b32 v136, 4, v1
    s_lshl_b32 s5, s28, 2
    v_add_u32 v136, s5, v136
    v_mul_u32_u24 v137, 528, v136
    v_and_b32 v138, 15, v1
    v_lshl_add_u32 v137, v138, 5, v137
    v_add_u32 v23, 90496, v137
    s_waitcnt vmcnt(3)
    s_barrier
    s_lshl_b32 s3, s28, 3
    s_add_u32 s3, s3, s2
    s_cmp_ge_u32 s3, 8
    s_cbranch_scc1 L_nordy
    v_mov_b32 v2, 1
    s_mov_b64 exec, 1
    buffer_store_byte v2, off, s[48:51], s2 sc1
    s_mov_b64 exec, -1
L_nordy:
    s_waitcnt lgkmcnt(5)
    v_mfma_f32_16x16x32_bf16 v[24:27], v[108:111], v[100:103], v[24:27]
    ds_read_b128 v[80:83], v9 offset:8192
    ds_read_b64_tr_b16 v[88:89], v13 offset:24576
    s_waitcnt lgkmcnt(6)
    v_mfma_f32_16x16x32_bf16 v[28:31], v[108:111], v[104:107], v[28:31]
    ds_read_b64_tr_b16 v[90:91], v13 offset:25088
    buffer_load_dwordx4 v7, s[36:39], s11 offen offset:2048 lds
    v_lshlrev_b32 v136, 10, v136
    v_lshl_add_u32 v127, v138, 4, v136
    s_and_b32 s5, s28, 3
    s_mul_i32 s5, s5, 2080
    s_add_u32 s5, s5, 98816
    v_add_u32 v17, s5, v4
    s_lshl_b32 s89, s27, 8
    s_add_u32 s89, s89, 17874944
    s_waitcnt lgkmcnt(5)
    v_mfma_f32_16x16x32_bf16 v[32:35], v[112:115], v[100:103], v[32:35]
    ds_read_b128 v[84:87], v9 offset:10240
    v_mov_b32 v146, 0x3f803f80
    s_mov_b32 s31, 0x3eb8aa3b
    s_lshr_b32 s5, s26, 3
    s_lshl_b32 s5, s5, 8
    s_add_u32 s91, s5, 17876992
    s_lshr_b32 s13, s28, 2
    s_lshl_b32 s13, s13, 3
    s_add_u32 s13, s13, s60
    v_mfma_f32_16x16x32_bf16 v[36:39], v[112:115], v[104:107], v[36:39]
    ds_read_b64_tr_b16 v[92:93], v13 offset:25600
    ds_read_b64_tr_b16 v[94:95], v13 offset:26112
    s_add_u32 m0, s64, 24576
    s_xor_b32 s10, s63, 384
    buffer_load_dwordx4 v6, s[32:35], s10 offen lds
    s_waitcnt lgkmcnt(6)
    v_mfma_f32_16x16x32_bf16 v[40:43], v[100:103], v[116:119], v[40:43]
    ds_read_b64_tr_b16 v[96:97], v13 offset:26624
    s_lshl_b32 s13, s13, 2
    s_and_b32 s14, s28, 3
    s_add_u32 s13, s13, s14
    s_lshr_b32 s14, s13, 1
    v_xor_b32 v143, s14, v1
    v_and_b32 v143, 7, v143
    v_lshrrev_b32 v142, 3, v1
    v_lshlrev_b32 v142, 13, v142
    v_mfma_f32_16x16x32_bf16 v[44:47], v[104:107], v[116:119], v[44:47]
    ds_read_b64_tr_b16 v[98:99], v13 offset:27136
    s_add_u32 m0, s100, 139264
    s_xor_b32 s10, s63, 384
    s_mul_i32 s11, s10, 1536
    buffer_load_dwordx4 v7, s[36:39], s11 offen lds
    v_lshl_add_u32 v142, v143, 4, v142
    s_lshl_b32 s14, s13, 7
    v_add_u32 v142, s14, v142
    s_lshl_b32 s13, s61, 3
    s_add_u32 s13, s13, s60
    s_lshl_b32 s13, s13, 3
    s_add_u32 s13, s13, s28
    s_lshl_b32 s13, s13, 3
    s_waitcnt lgkmcnt(5)
    v_mfma_f32_16x16x32_bf16 v[24:27], v[88:91], v[80:83], v[24:27]
    ds_read_b128 v[100:103], v10 offset:8192
    ds_read_b64_tr_b16 v[108:109], v13 offset:36864
    s_waitcnt lgkmcnt(6)
    v_mfma_f32_16x16x32_bf16 v[28:31], v[88:91], v[84:87], v[28:31]
    ds_read_b64_tr_b16 v[110:111], v13 offset:37376
    buffer_load_dwordx4 v7, s[36:39], s11 offen offset:1024 lds
    s_add_u32 s13, s13, 17891328
    v_lshrrev_b32 v166, 5, v1
    v_and_b32 v167, 31, v1
    v_add_u32 v167, 18, v167
    v_lshlrev_b32 v168, 2, v166
    v_sub_u32 v168, v167, v168
    v_mov_b32 v170, 0x5555
    v_mov_b32 v171, 0
    s_waitcnt lgkmcnt(5)
    v_mfma_f32_16x16x32_bf16 v[32:35], v[92:95], v[80:83], v[32:35]
    ds_read_b128 v[104:107], v10 offset:10240
    v_lshlrev_b64 v[170:171], v168, v[170:171]
    s_mov_b32 s4, 0xff800000
    s_lshr_b32 s6, s28, 2
    s_add_u32 s6, s6, s61
    s_cmp_eq_u32 s6, 0
    s_cselect_b32 s6, 0, -1
    v_and_b32 v170, s6, v170
    v_not_b32 v170, v170
    v_not_b32 v171, v171
    v_mfma_f32_16x16x32_bf16 v[36:39], v[92:95], v[84:87], v[36:39]
    ds_read_b64_tr_b16 v[112:113], v13 offset:37888
    ds_read_b64_tr_b16 v[114:115], v13 offset:38400
    buffer_load_dwordx4 v7, s[36:39], s11 offen offset:2048 lds
    s_waitcnt lgkmcnt(6)
    v_mfma_f32_16x16x32_bf16 v[40:43], v[80:83], v[96:99], v[40:43]
    ds_read_b64_tr_b16 v[116:117], v13 offset:38912
    v_bfe_i32 v176, v171, 0, 1
    v_bfe_i32 v177, v171, 1, 1
    v_bfe_i32 v178, v171, 2, 1
    v_bfe_i32 v179, v171, 3, 1
    v_bfe_i32 v180, v171, 8, 1
    v_bfe_i32 v181, v171, 9, 1
    v_bfe_i32 v182, v171, 10, 1
    v_bfe_i32 v183, v171, 11, 1
    v_mfma_f32_16x16x32_bf16 v[44:47], v[84:87], v[96:99], v[44:47]
    ds_read_b64_tr_b16 v[118:119], v13 offset:39424
    s_add_u32 m0, s64, 32768
    s_xor_b32 s10, s63, 512
    buffer_load_dwordx4 v6, s[32:35], s10 offen lds
    v_bfe_i32 v200, v170, 16, 1
    v_bfe_i32 v184, v171, 16, 1
    v_bfe_i32 v201, v170, 17, 1
    v_bfe_i32 v185, v171, 17, 1
    v_bfe_i32 v202, v170, 18, 1
    v_bfe_i32 v186, v171, 18, 1
    v_bfe_i32 v203, v170, 19, 1
    v_bfe_i32 v187, v171, 19, 1
    s_waitcnt vmcnt(5)
    s_barrier
    s_waitcnt lgkmcnt(5)
    v_mfma_f32_16x16x32_bf16 v[24:27], v[108:111], v[100:103], v[24:27]
    ds_read_b128 v[80:83], v9 offset:16384
    ds_read_b64_tr_b16 v[88:89], v14 offset:0
    s_waitcnt lgkmcnt(6)
    v_mfma_f32_16x16x32_bf16 v[28:31], v[108:111], v[104:107], v[28:31]
    ds_read_b64_tr_b16 v[90:91], v14 offset:512
    s_add_u32 m0, s100, 65536
    s_xor_b32 s10, s63, 512
    s_mul_i32 s11, s10, 1536
    buffer_load_dwordx4 v7, s[36:39], s11 offen lds
    v_bfe_i32 v204, v170, 24, 1
    v_bfe_i32 v188, v171, 24, 1
    v_bfe_i32 v205, v170, 25, 1
    v_bfe_i32 v189, v171, 25, 1
    v_bfe_i32 v206, v170, 26, 1
    v_bfe_i32 v190, v171, 26, 1
    v_bfe_i32 v207, v170, 27, 1
    v_bfe_i32 v191, v171, 27, 1
    s_mov_b32 s56, s16
    s_mov_b32 s57, s17
    s_mov_b32 s58, 1024
    s_mov_b32 s59, 0x00020000
    buffer_load_dwordx4 v[132:135], v145, s[56:59], 0 offen
    s_waitcnt lgkmcnt(5)
    v_mfma_f32_16x16x32_bf16 v[32:35], v[112:115], v[100:103], v[32:35]
    ds_read_b128 v[84:87], v9 offset:18432
    v_and_b32 v176, s4, v176
    v_and_b32 v177, s4, v177
    v_and_b32 v178, s4, v178
    v_and_b32 v179, s4, v179
    v_and_b32 v180, s4, v180
    v_and_b32 v181, s4, v181
    v_and_b32 v182, s4, v182
    v_and_b32 v183, s4, v183
    v_mfma_f32_16x16x32_bf16 v[36:39], v[112:115], v[104:107], v[36:39]
    ds_read_b64_tr_b16 v[92:93], v14 offset:1024
    ds_read_b64_tr_b16 v[94:95], v14 offset:1536
    buffer_load_dwordx4 v7, s[36:39], s11 offen offset:1024 lds
    s_waitcnt lgkmcnt(6)
    v_mfma_f32_16x16x32_bf16 v[40:43], v[100:103], v[116:119], v[40:43]
    ds_read_b64_tr_b16 v[96:97], v14 offset:2048
    v_and_b32 v184, s4, v184
    v_and_b32 v185, s4, v185
    v_and_b32 v186, s4, v186
    v_and_b32 v187, s4, v187
    v_and_b32 v188, s4, v188
    v_and_b32 v189, s4, v189
    v_and_b32 v190, s4, v190
    v_and_b32 v191, s4, v191
    v_mfma_f32_16x16x32_bf16 v[44:47], v[104:107], v[116:119], v[44:47]
    ds_read_b64_tr_b16 v[98:99], v14 offset:2560
    buffer_load_dwordx4 v7, s[36:39], s11 offen offset:2048 lds
    v_and_b32 v200, s4, v200
    v_and_b32 v201, s4, v201
    v_and_b32 v202, s4, v202
    v_and_b32 v203, s4, v203
    v_and_b32 v204, s4, v204
    v_and_b32 v205, s4, v205
    v_and_b32 v206, s4, v206
    v_and_b32 v207, s4, v207
    s_waitcnt lgkmcnt(5)
    v_mfma_f32_16x16x32_bf16 v[24:27], v[88:91], v[80:83], v[24:27]
    ds_read_b128 v[100:103], v10 offset:16384
    ds_read_b64_tr_b16 v[108:109], v14 offset:12288
    s_waitcnt lgkmcnt(6)
    v_mfma_f32_16x16x32_bf16 v[28:31], v[88:91], v[84:87], v[28:31]
    ds_read_b64_tr_b16 v[110:111], v14 offset:12800
    s_add_u32 m0, s64, 40960
    s_xor_b32 s10, s63, 640
    buffer_load_dwordx4 v6, s[32:35], s10 offen lds
    v_and_b32 v166, 11, v1
    v_cmp_eq_u32 vcc, 0, v166
    v_cndmask_b32 v146, 0, v146, vcc
    s_waitcnt lgkmcnt(5)
    v_mfma_f32_16x16x32_bf16 v[32:35], v[92:95], v[80:83], v[32:35]
    ds_read_b128 v[104:107], v10 offset:18432
    v_mfma_f32_16x16x32_bf16 v[36:39], v[92:95], v[84:87], v[36:39]
    ds_read_b64_tr_b16 v[112:113], v14 offset:13312
    ds_read_b64_tr_b16 v[114:115], v14 offset:13824
    s_waitcnt lgkmcnt(6)
    v_mfma_f32_16x16x32_bf16 v[40:43], v[80:83], v[96:99], v[40:43]
    ds_read_b64_tr_b16 v[116:117], v14 offset:14336
    v_mfma_f32_16x16x32_bf16 v[44:47], v[84:87], v[96:99], v[44:47]
    ds_read_b64_tr_b16 v[118:119], v14 offset:14848
    s_waitcnt vmcnt(6)
    s_barrier
    s_waitcnt lgkmcnt(5)
    v_mfma_f32_16x16x32_bf16 v[24:27], v[108:111], v[100:103], v[24:27]
    ds_read_b128 v[80:83], v9 offset:24576
    ds_read_b64_tr_b16 v[88:89], v14 offset:24576
    s_waitcnt lgkmcnt(6)
    v_mfma_f32_16x16x32_bf16 v[28:31], v[108:111], v[104:107], v[28:31]
    ds_read_b64_tr_b16 v[90:91], v14 offset:25088
    s_add_u32 m0, s100, 90112
    s_xor_b32 s10, s63, 640
    s_mul_i32 s11, s10, 1536
    buffer_load_dwordx4 v7, s[36:39], s11 offen lds
    s_waitcnt lgkmcnt(5)
    v_mfma_f32_16x16x32_bf16 v[32:35], v[112:115], v[100:103], v[32:35]
    ds_read_b128 v[84:87], v9 offset:26624
    v_mfma_f32_16x16x32_bf16 v[36:39], v[112:115], v[104:107], v[36:39]
    ds_read_b64_tr_b16 v[92:93], v14 offset:25600
    ds_read_b64_tr_b16 v[94:95], v14 offset:26112
    buffer_load_dwordx4 v7, s[36:39], s11 offen offset:1024 lds
    s_waitcnt lgkmcnt(6)
    v_mfma_f32_16x16x32_bf16 v[40:43], v[100:103], v[116:119], v[40:43]
    ds_read_b64_tr_b16 v[96:97], v14 offset:26624
    v_mfma_f32_16x16x32_bf16 v[44:47], v[104:107], v[116:119], v[44:47]
    ds_read_b64_tr_b16 v[98:99], v14 offset:27136
    buffer_load_dwordx4 v7, s[36:39], s11 offen offset:2048 lds
    s_waitcnt lgkmcnt(5)
    v_mfma_f32_16x16x32_bf16 v[24:27], v[88:91], v[80:83], v[24:27]
    ds_read_b128 v[100:103], v10 offset:24576
    ds_read_b64_tr_b16 v[108:109], v14 offset:36864
    s_waitcnt lgkmcnt(6)
    v_mfma_f32_16x16x32_bf16 v[28:31], v[88:91], v[84:87], v[28:31]
    ds_read_b64_tr_b16 v[110:111], v14 offset:37376
    s_add_u32 m0, s64, 49152
    s_xor_b32 s10, s63, 768
    buffer_load_dwordx4 v6, s[32:35], s10 offen lds
    s_waitcnt lgkmcnt(5)
    v_mfma_f32_16x16x32_bf16 v[32:35], v[92:95], v[80:83], v[32:35]
    ds_read_b128 v[104:107], v10 offset:26624
    v_mfma_f32_16x16x32_bf16 v[36:39], v[92:95], v[84:87], v[36:39]
    ds_read_b64_tr_b16 v[112:113], v14 offset:37888
    ds_read_b64_tr_b16 v[114:115], v14 offset:38400
    s_waitcnt lgkmcnt(6)
    v_mfma_f32_16x16x32_bf16 v[40:43], v[80:83], v[96:99], v[40:43]
    ds_read_b64_tr_b16 v[116:117], v14 offset:38912
    v_mfma_f32_16x16x32_bf16 v[44:47], v[84:87], v[96:99], v[44:47]
    ds_read_b64_tr_b16 v[118:119], v14 offset:39424
    s_waitcnt vmcnt(5)
    s_barrier
    s_waitcnt lgkmcnt(5)
    v_mfma_f32_16x16x32_bf16 v[24:27], v[108:111], v[100:103], v[24:27]
    ds_read_b128 v[80:83], v9 offset:32768
    ds_read_b64_tr_b16 v[88:89], v13 offset:0
    s_waitcnt lgkmcnt(6)
    v_mfma_f32_16x16x32_bf16 v[28:31], v[108:111], v[104:107], v[28:31]
    ds_read_b64_tr_b16 v[90:91], v13 offset:512
    s_add_u32 m0, s100, 114688
    s_xor_b32 s10, s63, 768
    s_mul_i32 s11, s10, 1536
    buffer_load_dwordx4 v7, s[36:39], s11 offen lds
    s_waitcnt lgkmcnt(5)
    v_mfma_f32_16x16x32_bf16 v[32:35], v[112:115], v[100:103], v[32:35]
    ds_read_b128 v[84:87], v9 offset:34816
    v_mfma_f32_16x16x32_bf16 v[36:39], v[112:115], v[104:107], v[36:39]
    ds_read_b64_tr_b16 v[92:93], v13 offset:1024
    ds_read_b64_tr_b16 v[94:95], v13 offset:1536
    buffer_load_dwordx4 v7, s[36:39], s11 offen offset:1024 lds
    s_waitcnt lgkmcnt(6)
    v_mfma_f32_16x16x32_bf16 v[40:43], v[100:103], v[116:119], v[40:43]
    ds_read_b64_tr_b16 v[96:97], v13 offset:2048
    v_mfma_f32_16x16x32_bf16 v[44:47], v[104:107], v[116:119], v[44:47]
    ds_read_b64_tr_b16 v[98:99], v13 offset:2560
    buffer_load_dwordx4 v7, s[36:39], s11 offen offset:2048 lds
    s_waitcnt lgkmcnt(5)
    v_mfma_f32_16x16x32_bf16 v[24:27], v[88:91], v[80:83], v[24:27]
    ds_read_b128 v[100:103], v10 offset:32768
    ds_read_b64_tr_b16 v[108:109], v13 offset:12288
    s_waitcnt lgkmcnt(6)
    v_mfma_f32_16x16x32_bf16 v[28:31], v[88:91], v[84:87], v[28:31]
    ds_read_b64_tr_b16 v[110:111], v13 offset:12800
    s_add_u32 m0, s64, 57344
    s_xor_b32 s10, s63, 896
    buffer_load_dwordx4 v6, s[32:35], s10 offen lds
    s_waitcnt lgkmcnt(5)
    v_mfma_f32_16x16x32_bf16 v[32:35], v[92:95], v[80:83], v[32:35]
    ds_read_b128 v[104:107], v10 offset:34816
    v_mfma_f32_16x16x32_bf16 v[36:39], v[92:95], v[84:87], v[36:39]
    ds_read_b64_tr_b16 v[112:113], v13 offset:13312
    ds_read_b64_tr_b16 v[114:115], v13 offset:13824
    s_mov_b64 exec, 0xffff
    buffer_load_dword v144, v156, s[40:43], 0 offen
    s_mov_b64 exec, -1
    s_waitcnt lgkmcnt(6)
    v_mfma_f32_16x16x32_bf16 v[40:43], v[80:83], v[96:99], v[40:43]
    ds_read_b64_tr_b16 v[116:117], v13 offset:14336
    v_mfma_f32_16x16x32_bf16 v[44:47], v[84:87], v[96:99], v[44:47]
    ds_read_b64_tr_b16 v[118:119], v13 offset:14848
    s_waitcnt vmcnt(6)
    s_barrier
    s_waitcnt lgkmcnt(5)
    v_mfma_f32_16x16x32_bf16 v[24:27], v[108:111], v[100:103], v[24:27]
    ds_read_b128 v[80:83], v9 offset:40960
    ds_read_b64_tr_b16 v[88:89], v13 offset:24576
    s_waitcnt lgkmcnt(6)
    v_mfma_f32_16x16x32_bf16 v[28:31], v[108:111], v[104:107], v[28:31]
    ds_read_b64_tr_b16 v[90:91], v13 offset:25088
    s_add_u32 m0, s100, 139264
    s_xor_b32 s10, s63, 896
    s_mul_i32 s11, s10, 1536
    buffer_load_dwordx4 v7, s[36:39], s11 offen lds
    v_lshl_or_b32 v152, v153, 16, v152
    v_lshl_or_b32 v153, v155, 16, v154
    s_waitcnt lgkmcnt(5)
    v_mfma_f32_16x16x32_bf16 v[32:35], v[112:115], v[100:103], v[32:35]
    ds_read_b128 v[84:87], v9 offset:43008
    v_mfma_f32_16x16x32_bf16 v[36:39], v[112:115], v[104:107], v[36:39]
    ds_read_b64_tr_b16 v[92:93], v13 offset:25600
    ds_read_b64_tr_b16 v[94:95], v13 offset:26112
    buffer_load_dwordx4 v7, s[36:39], s11 offen offset:1024 lds
    s_waitcnt lgkmcnt(6)
    v_mfma_f32_16x16x32_bf16 v[40:43], v[100:103], v[116:119], v[40:43]
    ds_read_b64_tr_b16 v[96:97], v13 offset:26624
    v_mfma_f32_16x16x32_bf16 v[44:47], v[104:107], v[116:119], v[44:47]
    ds_read_b64_tr_b16 v[98:99], v13 offset:27136
    buffer_load_dwordx4 v7, s[36:39], s11 offen offset:2048 lds
    s_waitcnt lgkmcnt(5)
    v_mfma_f32_16x16x32_bf16 v[24:27], v[88:91], v[80:83], v[24:27]
    ds_read_b128 v[100:103], v10 offset:40960
    ds_read_b64_tr_b16 v[108:109], v13 offset:36864
    s_waitcnt lgkmcnt(6)
    v_mfma_f32_16x16x32_bf16 v[28:31], v[88:91], v[84:87], v[28:31]
    ds_read_b64_tr_b16 v[110:111], v13 offset:37376
    s_waitcnt lgkmcnt(5)
    v_mfma_f32_16x16x32_bf16 v[32:35], v[92:95], v[80:83], v[32:35]
    ds_read_b128 v[104:107], v10 offset:43008
    v_mfma_f32_16x16x32_bf16 v[36:39], v[92:95], v[84:87], v[36:39]
    ds_read_b64_tr_b16 v[112:113], v13 offset:37888
    ds_read_b64_tr_b16 v[114:115], v13 offset:38400
    s_waitcnt lgkmcnt(6)
    v_mfma_f32_16x16x32_bf16 v[40:43], v[80:83], v[96:99], v[40:43]
    ds_read_b64_tr_b16 v[116:117], v13 offset:38912
    v_mfma_f32_16x16x32_bf16 v[44:47], v[84:87], v[96:99], v[44:47]
    ds_read_b64_tr_b16 v[118:119], v13 offset:39424
    s_waitcnt vmcnt(5)
    s_barrier
    s_waitcnt lgkmcnt(5)
    v_mfma_f32_16x16x32_bf16 v[24:27], v[108:111], v[100:103], v[24:27]
    ds_read_b128 v[80:83], v9 offset:49152
    ds_read_b64_tr_b16 v[88:89], v14 offset:0
    s_waitcnt lgkmcnt(6)
    v_mfma_f32_16x16x32_bf16 v[28:31], v[108:111], v[104:107], v[28:31]
    ds_read_b64_tr_b16 v[90:91], v14 offset:512
    s_add_u32 m0, s100, 65536
    s_xor_b32 s10, s63, 0
    s_mul_i32 s11, s10, 1536
    buffer_load_dwordx4 v7, s[40:43], s11 offen lds
    s_waitcnt lgkmcnt(5)
    v_mfma_f32_16x16x32_bf16 v[32:35], v[112:115], v[100:103], v[32:35]
    ds_read_b128 v[84:87], v9 offset:51200
    v_mfma_f32_16x16x32_bf16 v[36:39], v[112:115], v[104:107], v[36:39]
    ds_read_b64_tr_b16 v[92:93], v14 offset:1024
    ds_read_b64_tr_b16 v[94:95], v14 offset:1536
    buffer_load_dwordx4 v7, s[40:43], s11 offen offset:1024 lds
    s_waitcnt lgkmcnt(6)
    v_mfma_f32_16x16x32_bf16 v[40:43], v[100:103], v[116:119], v[40:43]
    ds_read_b64_tr_b16 v[96:97], v14 offset:2048
    v_mfma_f32_16x16x32_bf16 v[44:47], v[104:107], v[116:119], v[44:47]
    ds_read_b64_tr_b16 v[98:99], v14 offset:2560
    buffer_load_dwordx4 v7, s[40:43], s11 offen offset:2048 lds
    s_waitcnt lgkmcnt(5)
    v_mfma_f32_16x16x32_bf16 v[24:27], v[88:91], v[80:83], v[24:27]
    ds_read_b128 v[100:103], v10 offset:49152
    ds_read_b64_tr_b16 v[108:109], v14 offset:12288
    s_waitcnt lgkmcnt(6)
    v_mfma_f32_16x16x32_bf16 v[28:31], v[88:91], v[84:87], v[28:31]
    ds_read_b64_tr_b16 v[110:111], v14 offset:12800
    s_waitcnt lgkmcnt(5)
    v_mfma_f32_16x16x32_bf16 v[32:35], v[92:95], v[80:83], v[32:35]
    ds_read_b128 v[104:107], v10 offset:51200
    v_mfma_f32_16x16x32_bf16 v[36:39], v[92:95], v[84:87], v[36:39]
    ds_read_b64_tr_b16 v[112:113], v14 offset:13312
    ds_read_b64_tr_b16 v[114:115], v14 offset:13824
    s_waitcnt lgkmcnt(6)
    v_mfma_f32_16x16x32_bf16 v[40:43], v[80:83], v[96:99], v[40:43]
    ds_read_b64_tr_b16 v[116:117], v14 offset:14336
    v_mfma_f32_16x16x32_bf16 v[44:47], v[84:87], v[96:99], v[44:47]
    ds_read_b64_tr_b16 v[118:119], v14 offset:14848
    s_waitcnt vmcnt(3)
    s_waitcnt lgkmcnt(0)
    s_barrier
    v_mfma_f32_16x16x32_bf16 v[24:27], v[108:111], v[100:103], v[24:27]
    ds_read_b128 v[80:83], v9 offset:57344
    ds_read_b64_tr_b16 v[88:89], v14 offset:24576
    v_mfma_f32_16x16x32_bf16 v[28:31], v[108:111], v[104:107], v[28:31]
    ds_read_b64_tr_b16 v[90:91], v14 offset:25088
    s_add_u32 m0, s100, 90112
    s_xor_b32 s10, s63, 128
    s_mul_i32 s11, s10, 1536
    buffer_load_dwordx4 v7, s[40:43], s11 offen lds
    v_mfma_f32_16x16x32_bf16 v[32:35], v[112:115], v[100:103], v[32:35]
    ds_read_b128 v[84:87], v9 offset:59392
    v_mfma_f32_16x16x32_bf16 v[36:39], v[112:115], v[104:107], v[36:39]
    ds_read_b64_tr_b16 v[92:93], v14 offset:25600
    ds_read_b64_tr_b16 v[94:95], v14 offset:26112
    buffer_load_dwordx4 v7, s[40:43], s11 offen offset:1024 lds
    v_mfma_f32_16x16x32_bf16 v[40:43], v[100:103], v[116:119], v[40:43]
    ds_read_b64_tr_b16 v[96:97], v14 offset:26624
    v_mfma_f32_16x16x32_bf16 v[44:47], v[104:107], v[116:119], v[44:47]
    ds_read_b64_tr_b16 v[98:99], v14 offset:27136
    buffer_load_dwordx4 v7, s[40:43], s11 offen offset:2048 lds
    s_waitcnt lgkmcnt(5)
    v_mfma_f32_16x16x32_bf16 v[24:27], v[88:91], v[80:83], v[24:27]
    ds_read_b128 v[100:103], v10 offset:57344
    ds_read_b64_tr_b16 v[108:109], v14 offset:36864
    s_waitcnt lgkmcnt(6)
    v_mfma_f32_16x16x32_bf16 v[28:31], v[88:91], v[84:87], v[28:31]
    ds_read_b64_tr_b16 v[110:111], v14 offset:37376
    s_add_u32 m0, s100, 114688
    s_xor_b32 s10, s63, 256
    s_mul_i32 s11, s10, 1536
    buffer_load_dwordx4 v7, s[40:43], s11 offen lds
    ds_read_b128 v[128:131], v142
    s_waitcnt lgkmcnt(6)
    v_mfma_f32_16x16x32_bf16 v[32:35], v[92:95], v[80:83], v[32:35]
    ds_read_b128 v[104:107], v10 offset:59392
    v_mfma_f32_16x16x32_bf16 v[36:39], v[92:95], v[84:87], v[36:39]
    ds_read_b64_tr_b16 v[112:113], v14 offset:37888
    ds_read_b64_tr_b16 v[114:115], v14 offset:38400
    buffer_load_dwordx4 v7, s[40:43], s11 offen offset:1024 lds
    s_waitcnt lgkmcnt(7)
    v_mfma_f32_16x16x32_bf16 v[40:43], v[80:83], v[96:99], v[40:43]
    ds_read_b64_tr_b16 v[116:117], v14 offset:38912
    v_mfma_f32_16x16x32_bf16 v[44:47], v[84:87], v[96:99], v[44:47]
    ds_read_b64_tr_b16 v[118:119], v14 offset:39424
    buffer_load_dwordx4 v7, s[40:43], s11 offen offset:2048 lds
    s_waitcnt vmcnt(6)
    s_waitcnt lgkmcnt(0)
    s_barrier
    v_mfma_f32_16x16x32_bf16 v[24:27], v[108:111], v[100:103], v[24:27]
    ds_read_b128 v[80:83], v9 offset:0
    ds_read_b64_tr_b16 v[88:89], v13 offset:0
    v_mfma_f32_16x16x32_bf16 v[28:31], v[108:111], v[104:107], v[28:31]
    ds_read_b64_tr_b16 v[90:91], v13 offset:512
    s_add_u32 m0, s100, 139264
    s_xor_b32 s10, s63, 384
    s_mul_i32 s11, s10, 1536
    buffer_load_dwordx4 v7, s[40:43], s11 offen lds
    v_mfma_f32_16x16x32_bf16 v[32:35], v[112:115], v[100:103], v[32:35]
    ds_read_b128 v[84:87], v9 offset:2048
    v_mfma_f32_16x16x32_bf16 v[36:39], v[112:115], v[104:107], v[36:39]
    ds_read_b64_tr_b16 v[92:93], v13 offset:1024
    ds_read_b64_tr_b16 v[94:95], v13 offset:1536
    buffer_load_dwordx4 v7, s[40:43], s11 offen offset:1024 lds
    v_mfma_f32_16x16x32_bf16 v[40:43], v[100:103], v[116:119], v[40:43]
    ds_read_b64_tr_b16 v[96:97], v13 offset:2048
    v_mfma_f32_16x16x32_bf16 v[44:47], v[104:107], v[116:119], v[44:47]
    ds_read_b64_tr_b16 v[98:99], v13 offset:2560
    buffer_load_dwordx4 v7, s[40:43], s11 offen offset:2048 lds
    s_waitcnt lgkmcnt(5)
    v_mfma_f32_16x16x32_bf16 v[56:59], v[88:91], v[80:83], 0
    ds_read_b128 v[100:103], v10 offset:0
    ds_read_b64_tr_b16 v[108:109], v13 offset:12288
    s_waitcnt lgkmcnt(6)
    v_mfma_f32_16x16x32_bf16 v[60:63], v[88:91], v[84:87], 0
    ds_read_b64_tr_b16 v[110:111], v13 offset:12800
    s_lshl_b32 s29, s73, 6
    s_add_u32 s29, s29, s72
    s_lshl_b32 s29, s29, 11
    s_add_u32 s30, s29, 4194304
    v_cvt_pk_bf16_f32 v32, v32, v33
    v_cvt_pk_bf16_f32 v33, v34, v35
    v_cvt_pk_bf16_f32 v34, v36, v37
    v_cvt_pk_bf16_f32 v35, v38, v39
    v_mul_f32 v24, s31, v24
    v_mul_f32 v25, s31, v25
    s_waitcnt lgkmcnt(5)
    v_mfma_f32_16x16x32_bf16 v[64:67], v[92:95], v[80:83], 0
    ds_read_b128 v[104:107], v10 offset:2048
    v_cvt_pk_bf16_f32 v40, v40, v41
    v_cvt_pk_bf16_f32 v41, v42, v43
    v_permlane16_swap_b32 v32, v34
    v_permlane16_swap_b32 v33, v35
    v_cvt_pk_bf16_f32 v42, v44, v45
    v_cvt_pk_bf16_f32 v43, v46, v47
    v_mul_f32 v26, s31, v26
    v_mul_f32 v27, s31, v27
    v_mfma_f32_16x16x32_bf16 v[68:71], v[92:95], v[84:87], 0
    ds_read_b64_tr_b16 v[112:113], v13 offset:13312
    ds_read_b64_tr_b16 v[114:115], v13 offset:13824
    s_waitcnt lgkmcnt(6)
    v_mfma_f32_16x16x32_bf16 v[72:75], v[80:83], v[96:99], 0
    ds_read_b64_tr_b16 v[116:117], v13 offset:14336
    buffer_store_dwordx4 v[32:35], v159, s[44:47], s30 offen sc1
    v_permlane16_swap_b32 v40, v42
    v_permlane16_swap_b32 v41, v43
    v_mul_f32 v28, s31, v28
    v_mul_f32 v29, s31, v29
    v_mul_f32 v30, s31, v30
    v_mul_f32 v31, s31, v31
    v_mfma_f32_16x16x32_bf16 v[76:79], v[84:87], v[96:99], 0
    ds_read_b64_tr_b16 v[118:119], v13 offset:14848
    v_permlane32_swap_b32 v40, v42
    v_permlane32_swap_b32 v41, v43
    v_cvt_pk_bf16_f32 v24, v24, v25
    v_cvt_pk_bf16_f32 v25, v26, v27
    v_cvt_pk_bf16_f32 v26, v28, v29
    v_cvt_pk_bf16_f32 v27, v30, v31
    s_add_u32 s30, s29, 8388608
    s_waitcnt vmcnt(7)
    s_barrier
    s_waitcnt lgkmcnt(5)
    v_mfma_f32_16x16x32_bf16 v[56:59], v[108:111], v[100:103], v[56:59]
    ds_read_b128 v[80:83], v9 offset:8192
    ds_read_b64_tr_b16 v[88:89], v13 offset:24576
    s_waitcnt lgkmcnt(6)
    v_mfma_f32_16x16x32_bf16 v[60:63], v[108:111], v[104:107], v[60:63]
    ds_read_b64_tr_b16 v[90:91], v13 offset:25088
    buffer_store_dwordx4 v[40:43], v159, s[44:47], s30 offen sc1
    v_permlane16_swap_b32 v24, v26
    v_permlane16_swap_b32 v25, v27
    s_cmp_lg_u32 s28, 0
    s_cbranch_scc1 L_nordy2
    buffer_load_dword v124, v5, s[48:51], 0 offen sc1
L_nordy2:
    s_waitcnt lgkmcnt(5)
    v_mfma_f32_16x16x32_bf16 v[64:67], v[112:115], v[100:103], v[64:67]
    ds_read_b128 v[84:87], v9 offset:10240
    buffer_store_dwordx4 v[24:27], v159, s[44:47], s29 offen sc1
    v_mfma_f32_16x16x32_bf16 v[68:71], v[112:115], v[104:107], v[68:71]
    ds_read_b64_tr_b16 v[92:93], v13 offset:25600
    ds_read_b64_tr_b16 v[94:95], v13 offset:26112
    s_waitcnt lgkmcnt(6)
    v_mfma_f32_16x16x32_bf16 v[72:75], v[100:103], v[116:119], v[72:75]
    ds_read_b64_tr_b16 v[96:97], v13 offset:26624
    v_dot2_f32_bf16 v136, v128, v132, 0
    v_dot2_f32_bf16 v137, v129, v133, 0
    v_dot2_f32_bf16 v138, v130, v134, 0
    v_mfma_f32_16x16x32_bf16 v[76:79], v[104:107], v[116:119], v[76:79]
    ds_read_b64_tr_b16 v[98:99], v13 offset:27136
    v_dot2_f32_bf16 v139, v131, v135, 0
    s_nop 2
    v_add_f32 v136, v136, v137
    s_waitcnt lgkmcnt(5)
    v_mfma_f32_16x16x32_bf16 v[56:59], v[88:91], v[80:83], v[56:59]
    ds_read_b128 v[100:103], v10 offset:8192
    ds_read_b64_tr_b16 v[108:109], v13 offset:36864
    s_waitcnt lgkmcnt(6)
    v_mfma_f32_16x16x32_bf16 v[60:63], v[88:91], v[84:87], v[60:63]
    ds_read_b64_tr_b16 v[110:111], v13 offset:37376
    v_add_f32 v138, v138, v139
    v_add_f32 v136, v136, v138
    s_nop 1
    s_waitcnt lgkmcnt(5)
    v_mfma_f32_16x16x32_bf16 v[64:67], v[92:95], v[80:83], v[64:67]
    ds_read_b128 v[104:107], v10 offset:10240
    v_add_f32_dpp v136, v136, v136 row_ror:8 row_mask:0xf bank_mask:0xf
    s_nop 1
    v_add_f32_dpp v136, v136, v136 row_ror:4 row_mask:0xf bank_mask:0xf
    v_mfma_f32_16x16x32_bf16 v[68:71], v[92:95], v[84:87], v[68:71]
    ds_read_b64_tr_b16 v[112:113], v13 offset:37888
    ds_read_b64_tr_b16 v[114:115], v13 offset:38400
    s_waitcnt lgkmcnt(6)
    v_mfma_f32_16x16x32_bf16 v[72:75], v[80:83], v[96:99], v[72:75]
    ds_read_b64_tr_b16 v[116:117], v13 offset:38912
    s_nop 1
    v_add_f32_dpp v136, v136, v136 row_ror:2 row_mask:0xf bank_mask:0xf
    s_nop 1
    v_mfma_f32_16x16x32_bf16 v[76:79], v[84:87], v[96:99], v[76:79]
    ds_read_b64_tr_b16 v[118:119], v13 offset:39424
    v_add_f32_dpp v136, v136, v136 row_ror:1 row_mask:0xf bank_mask:0xf
    s_nop 1
    v_mov_b32 v137, v136
    s_waitcnt vmcnt(6)
    s_barrier
    s_waitcnt lgkmcnt(5)
    v_mfma_f32_16x16x32_bf16 v[56:59], v[108:111], v[100:103], v[56:59]
    ds_read_b128 v[80:83], v9 offset:16384
    ds_read_b64_tr_b16 v[88:89], v14 offset:0
    s_waitcnt lgkmcnt(6)
    v_mfma_f32_16x16x32_bf16 v[60:63], v[108:111], v[104:107], v[60:63]
    ds_read_b64_tr_b16 v[90:91], v14 offset:512
    s_add_u32 m0, s100, 65536
    s_xor_b32 s10, s63, 512
    s_mul_i32 s11, s10, 1536
    buffer_load_dwordx4 v7, s[40:43], s11 offen lds
    s_nop 1
    v_permlane16_swap_b32 v136, v137
    s_nop 1
    s_waitcnt lgkmcnt(5)
    v_mfma_f32_16x16x32_bf16 v[64:67], v[112:115], v[100:103], v[64:67]
    ds_read_b128 v[84:87], v9 offset:18432
    v_add_f32 v136, v136, v137
    v_mov_b32 v137, v136
    s_nop 1
    v_mfma_f32_16x16x32_bf16 v[68:71], v[112:115], v[104:107], v[68:71]
    ds_read_b64_tr_b16 v[92:93], v14 offset:1024
    ds_read_b64_tr_b16 v[94:95], v14 offset:1536
    buffer_load_dwordx4 v7, s[40:43], s11 offen offset:1024 lds
    s_waitcnt lgkmcnt(6)
    v_mfma_f32_16x16x32_bf16 v[72:75], v[100:103], v[116:119], v[72:75]
    ds_read_b64_tr_b16 v[96:97], v14 offset:2048
    v_permlane32_swap_b32 v136, v137
    s_nop 1
    v_add_f32 v142, v136, v137
    v_mfma_f32_16x16x32_bf16 v[76:79], v[104:107], v[116:119], v[76:79]
    ds_read_b64_tr_b16 v[98:99], v14 offset:2560
    buffer_load_dwordx4 v7, s[40:43], s11 offen offset:2048 lds
    v_cvt_pk_bf16_f32 v142, v142, v142
    v_and_b32 v142, 0xffff0000, v142
    v_mul_f32 v142, 0xbfb8aa3b, v142
    s_waitcnt lgkmcnt(5)
    v_mfma_f32_16x16x32_bf16 v[56:59], v[88:91], v[80:83], v[56:59]
    ds_read_b128 v[100:103], v10 offset:16384
    ds_read_b64_tr_b16 v[108:109], v14 offset:12288
    s_waitcnt lgkmcnt(6)
    v_mfma_f32_16x16x32_bf16 v[60:63], v[88:91], v[84:87], v[60:63]
    ds_read_b64_tr_b16 v[110:111], v14 offset:12800
    v_exp_f32 v142, v142
    s_nop 0
    v_add_f32 v142, 1.0, v142
    s_waitcnt lgkmcnt(5)
    v_mfma_f32_16x16x32_bf16 v[64:67], v[92:95], v[80:83], v[64:67]
    ds_read_b128 v[104:107], v10 offset:18432
    v_rcp_f32 v142, v142
    s_nop 0
    v_cvt_pk_bf16_f32 v142, v142, v142
    v_mfma_f32_16x16x32_bf16 v[68:71], v[92:95], v[84:87], v[68:71]
    ds_read_b64_tr_b16 v[112:113], v14 offset:13312
    ds_read_b64_tr_b16 v[114:115], v14 offset:13824
    s_waitcnt lgkmcnt(6)
    v_mfma_f32_16x16x32_bf16 v[72:75], v[80:83], v[96:99], v[72:75]
    ds_read_b64_tr_b16 v[116:117], v14 offset:14336
    v_and_b32 v140, 0xffff0000, v142
    v_sub_f32 v142, 1.0, v140
    v_cvt_pk_bf16_f32 v142, v142, v142
    v_mfma_f32_16x16x32_bf16 v[76:79], v[84:87], v[96:99], v[76:79]
    ds_read_b64_tr_b16 v[118:119], v14 offset:14848
    v_and_b32 v141, 0xffff0000, v142
    s_mov_b64 exec, 1
    buffer_store_dwordx2 v[140:141], off, s[44:47], s13 sc1
    s_mov_b64 exec, -1
    s_waitcnt vmcnt(7)
    s_waitcnt vmcnt(4)
    s_cmp_lg_u32 s28, 0
    s_cbranch_scc1 L_rdy_skip
    s_mov_b32 s65, 400000
    s_mov_b32 s3, 0x01010101
L_dbg1:
    v_cmp_eq_u32 vcc, s3, v124
    s_and_b32 s10, vcc_lo, 3
    s_cmp_eq_u32 s10, 3
    s_cbranch_scc1 L_dbg1_ok
    s_sub_u32 s65, s65, 1
    s_cbranch_scc1 L_dbg1_ok
    buffer_load_dword v124, v5, s[48:51], 0 offen sc1
    s_waitcnt vmcnt(0)
    s_branch L_dbg1
L_dbg1_ok:
L_rdy_skip:
    s_barrier
    s_cmp_lg_u32 s28, 0
    s_cbranch_scc1 L_nokf
    v_mov_b32 v3, 1
    s_mov_b64 exec, 15
    buffer_store_dword v3, v149, s[44:47], s99 offen sc1
    s_mov_b64 exec, -1
L_nokf:
    s_waitcnt lgkmcnt(5)
    v_mfma_f32_16x16x32_bf16 v[56:59], v[108:111], v[100:103], v[56:59]
    ds_read_b128 v[80:83], v9 offset:24576
    ds_read_b64_tr_b16 v[88:89], v14 offset:24576
    s_waitcnt lgkmcnt(6)
    v_mfma_f32_16x16x32_bf16 v[60:63], v[108:111], v[104:107], v[60:63]
    ds_read_b64_tr_b16 v[90:91], v14 offset:25088
    s_add_u32 m0, s100, 90112
    s_xor_b32 s10, s63, 640
    s_mul_i32 s11, s10, 1536
    buffer_load_dwordx4 v7, s[40:43], s11 offen lds
    s_waitcnt lgkmcnt(5)
    v_mfma_f32_16x16x32_bf16 v[64:67], v[112:115], v[100:103], v[64:67]
    ds_read_b128 v[84:87], v9 offset:26624
    v_mfma_f32_16x16x32_bf16 v[68:71], v[112:115], v[104:107], v[68:71]
    ds_read_b64_tr_b16 v[92:93], v14 offset:25600
    ds_read_b64_tr_b16 v[94:95], v14 offset:26112
    buffer_load_dwordx4 v7, s[40:43], s11 offen offset:1024 lds
    s_waitcnt lgkmcnt(6)
    v_mfma_f32_16x16x32_bf16 v[72:75], v[100:103], v[116:119], v[72:75]
    ds_read_b64_tr_b16 v[96:97], v14 offset:26624
    v_mfma_f32_16x16x32_bf16 v[76:79], v[104:107], v[116:119], v[76:79]
    ds_read_b64_tr_b16 v[98:99], v14 offset:27136
    buffer_load_dwordx4 v7, s[40:43], s11 offen offset:2048 lds
    s_waitcnt lgkmcnt(5)
    v_mfma_f32_16x16x32_bf16 v[56:59], v[88:91], v[80:83], v[56:59]
    ds_read_b128 v[100:103], v10 offset:24576
    ds_read_b64_tr_b16 v[108:109], v14 offset:36864
    s_waitcnt lgkmcnt(6)
    v_mfma_f32_16x16x32_bf16 v[60:63], v[88:91], v[84:87], v[60:63]
    ds_read_b64_tr_b16 v[110:111], v14 offset:37376
    s_waitcnt lgkmcnt(5)
    v_mfma_f32_16x16x32_bf16 v[64:67], v[92:95], v[80:83], v[64:67]
    ds_read_b128 v[104:107], v10 offset:26624
    v_mfma_f32_16x16x32_bf16 v[68:71], v[92:95], v[84:87], v[68:71]
    ds_read_b64_tr_b16 v[112:113], v14 offset:37888
    ds_read_b64_tr_b16 v[114:115], v14 offset:38400
    s_waitcnt lgkmcnt(6)
    v_mfma_f32_16x16x32_bf16 v[72:75], v[80:83], v[96:99], v[72:75]
    ds_read_b64_tr_b16 v[116:117], v14 offset:38912
    v_mfma_f32_16x16x32_bf16 v[76:79], v[84:87], v[96:99], v[76:79]
    ds_read_b64_tr_b16 v[118:119], v14 offset:39424
    s_cmp_lg_u32 s28, 0
    s_cbranch_scc1 L_fw1
    s_waitcnt vmcnt(5)
    s_branch L_fw2
L_fw1:
    s_waitcnt vmcnt(4)
L_fw2:
    s_barrier
    s_waitcnt lgkmcnt(5)
    v_mfma_f32_16x16x32_bf16 v[56:59], v[108:111], v[100:103], v[56:59]
    ds_read_b128 v[80:83], v9 offset:32768
    ds_read_b64_tr_b16 v[88:89], v13 offset:0
    s_waitcnt lgkmcnt(6)
    v_mfma_f32_16x16x32_bf16 v[60:63], v[108:111], v[104:107], v[60:63]
    ds_read_b64_tr_b16 v[90:91], v13 offset:512
    s_add_u32 m0, s100, 114688
    s_xor_b32 s10, s63, 768
    s_mul_i32 s11, s10, 1536
    buffer_load_dwordx4 v7, s[40:43], s11 offen lds
    s_waitcnt lgkmcnt(5)
    v_mfma_f32_16x16x32_bf16 v[64:67], v[112:115], v[100:103], v[64:67]
    ds_read_b128 v[84:87], v9 offset:34816
    v_mfma_f32_16x16x32_bf16 v[68:71], v[112:115], v[104:107], v[68:71]
    ds_read_b64_tr_b16 v[92:93], v13 offset:1024
    ds_read_b64_tr_b16 v[94:95], v13 offset:1536
    buffer_load_dwordx4 v7, s[40:43], s11 offen offset:1024 lds
    s_waitcnt lgkmcnt(6)
    v_mfma_f32_16x16x32_bf16 v[72:75], v[100:103], v[116:119], v[72:75]
    ds_read_b64_tr_b16 v[96:97], v13 offset:2048
    v_mfma_f32_16x16x32_bf16 v[76:79], v[104:107], v[116:119], v[76:79]
    ds_read_b64_tr_b16 v[98:99], v13 offset:2560
    buffer_load_dwordx4 v7, s[40:43], s11 offen offset:2048 lds
    s_waitcnt lgkmcnt(5)
    v_mfma_f32_16x16x32_bf16 v[56:59], v[88:91], v[80:83], v[56:59]
    ds_read_b128 v[100:103], v10 offset:32768
    ds_read_b64_tr_b16 v[108:109], v13 offset:12288
    s_waitcnt lgkmcnt(6)
    v_mfma_f32_16x16x32_bf16 v[60:63], v[88:91], v[84:87], v[60:63]
    ds_read_b64_tr_b16 v[110:111], v13 offset:12800
    s_waitcnt lgkmcnt(5)
    v_mfma_f32_16x16x32_bf16 v[64:67], v[92:95], v[80:83], v[64:67]
    ds_read_b128 v[104:107], v10 offset:34816
    v_mfma_f32_16x16x32_bf16 v[68:71], v[92:95], v[84:87], v[68:71]
    ds_read_b64_tr_b16 v[112:113], v13 offset:13312
    ds_read_b64_tr_b16 v[114:115], v13 offset:13824
    s_waitcnt lgkmcnt(6)
    v_mfma_f32_16x16x32_bf16 v[72:75], v[80:83], v[96:99], v[72:75]
    ds_read_b64_tr_b16 v[116:117], v13 offset:14336
    v_mfma_f32_16x16x32_bf16 v[76:79], v[84:87], v[96:99], v[76:79]
    ds_read_b64_tr_b16 v[118:119], v13 offset:14848
    s_waitcnt vmcnt(3)
    s_barrier
    s_waitcnt lgkmcnt(5)
    v_mfma_f32_16x16x32_bf16 v[56:59], v[108:111], v[100:103], v[56:59]
    ds_read_b128 v[80:83], v9 offset:40960
    ds_read_b64_tr_b16 v[88:89], v13 offset:24576
    s_waitcnt lgkmcnt(6)
    v_mfma_f32_16x16x32_bf16 v[60:63], v[108:111], v[104:107], v[60:63]
    ds_read_b64_tr_b16 v[90:91], v13 offset:25088
    s_add_u32 m0, s100, 139264
    s_xor_b32 s10, s63, 896
    s_mul_i32 s11, s10, 1536
    buffer_load_dwordx4 v7, s[40:43], s11 offen lds
    s_waitcnt lgkmcnt(5)
    v_mfma_f32_16x16x32_bf16 v[64:67], v[112:115], v[100:103], v[64:67]
    ds_read_b128 v[84:87], v9 offset:43008
    v_mfma_f32_16x16x32_bf16 v[68:71], v[112:115], v[104:107], v[68:71]
    ds_read_b64_tr_b16 v[92:93], v13 offset:25600
    ds_read_b64_tr_b16 v[94:95], v13 offset:26112
    buffer_load_dwordx4 v7, s[40:43], s11 offen offset:1024 lds
    s_waitcnt lgkmcnt(6)
    v_mfma_f32_16x16x32_bf16 v[72:75], v[100:103], v[116:119], v[72:75]
    ds_read_b64_tr_b16 v[96:97], v13 offset:26624
    v_mfma_f32_16x16x32_bf16 v[76:79], v[104:107], v[116:119], v[76:79]
    ds_read_b64_tr_b16 v[98:99], v13 offset:27136
    buffer_load_dwordx4 v7, s[40:43], s11 offen offset:2048 lds
    s_waitcnt lgkmcnt(5)
    v_mfma_f32_16x16x32_bf16 v[56:59], v[88:91], v[80:83], v[56:59]
    ds_read_b128 v[100:103], v10 offset:40960
    ds_read_b64_tr_b16 v[108:109], v13 offset:36864
    s_waitcnt lgkmcnt(6)
    v_mfma_f32_16x16x32_bf16 v[60:63], v[88:91], v[84:87], v[60:63]
    ds_read_b64_tr_b16 v[110:111], v13 offset:37376
    v_mov_b32 v7, v150
    v_mov_b32 v8, v151
    v_mov_b32 v6, v157
    s_waitcnt lgkmcnt(5)
    v_mfma_f32_16x16x32_bf16 v[64:67], v[92:95], v[80:83], v[64:67]
    ds_read_b128 v[104:107], v10 offset:43008
    v_mov_b32 v36, v146
    v_mov_b32 v37, v146
    v_mov_b32 v38, v146
    v_mfma_f32_16x16x32_bf16 v[68:71], v[92:95], v[84:87], v[68:71]
    ds_read_b64_tr_b16 v[112:113], v13 offset:37888
    ds_read_b64_tr_b16 v[114:115], v13 offset:38400
    s_waitcnt lgkmcnt(6)
    v_mfma_f32_16x16x32_bf16 v[72:75], v[80:83], v[96:99], v[72:75]
    ds_read_b64_tr_b16 v[116:117], v13 offset:38912
    v_mov_b32 v39, v146
    v_mov_b32 v40, v146
    v_mov_b32 v41, v146
    v_mfma_f32_16x16x32_bf16 v[76:79], v[84:87], v[96:99], v[76:79]
    ds_read_b64_tr_b16 v[118:119], v13 offset:39424
    v_mov_b32 v42, v146
    v_mov_b32 v43, v146
    v_mov_b32 v44, v146
    s_waitcnt vmcnt(3)
    s_barrier
    s_waitcnt lgkmcnt(5)
    v_mfma_f32_16x16x32_bf16 v[56:59], v[108:111], v[100:103], v[56:59]
    ds_read_b128 v[80:83], v9 offset:49152
    ds_read_b64_tr_b16 v[88:89], v14 offset:0
    s_waitcnt lgkmcnt(6)
    v_mfma_f32_16x16x32_bf16 v[60:63], v[108:111], v[104:107], v[60:63]
    ds_read_b64_tr_b16 v[90:91], v14 offset:512
    v_mov_b32 v45, v146
    v_mov_b32 v46, v146
    v_mov_b32 v47, v146
    s_waitcnt lgkmcnt(5)
    v_mfma_f32_16x16x32_bf16 v[64:67], v[112:115], v[100:103], v[64:67]
    ds_read_b128 v[84:87], v9 offset:51200
    v_mov_b32 v48, v146
    v_mov_b32 v49, v146
    v_mov_b32 v50, v146
    v_mfma_f32_16x16x32_bf16 v[68:71], v[112:115], v[104:107], v[68:71]
    ds_read_b64_tr_b16 v[92:93], v14 offset:1024
    ds_read_b64_tr_b16 v[94:95], v14 offset:1536
    s_waitcnt lgkmcnt(6)
    v_mfma_f32_16x16x32_bf16 v[72:75], v[100:103], v[116:119], v[72:75]
    ds_read_b64_tr_b16 v[96:97], v14 offset:2048
    v_mov_b32 v51, v146
    v_mfma_f32_16x16x32_bf16 v[76:79], v[104:107], v[116:119], v[76:79]
    ds_read_b64_tr_b16 v[98:99], v14 offset:2560
    buffer_load_dword v125, v5, s[44:47], s76 offen sc1
    s_waitcnt lgkmcnt(5)
    v_mfma_f32_16x16x32_bf16 v[56:59], v[88:91], v[80:83], v[56:59]
    ds_read_b128 v[100:103], v10 offset:49152
    ds_read_b64_tr_b16 v[108:109], v14 offset:12288
    s_waitcnt lgkmcnt(6)
    v_mfma_f32_16x16x32_bf16 v[60:63], v[88:91], v[84:87], v[60:63]
    ds_read_b64_tr_b16 v[110:111], v14 offset:12800
    s_waitcnt lgkmcnt(5)
    v_mfma_f32_16x16x32_bf16 v[64:67], v[92:95], v[80:83], v[64:67]
    ds_read_b128 v[104:107], v10 offset:51200
    v_mfma_f32_16x16x32_bf16 v[68:71], v[92:95], v[84:87], v[68:71]
    ds_read_b64_tr_b16 v[112:113], v14 offset:13312
    ds_read_b64_tr_b16 v[114:115], v14 offset:13824
    s_waitcnt lgkmcnt(6)
    v_mfma_f32_16x16x32_bf16 v[72:75], v[80:83], v[96:99], v[72:75]
    ds_read_b64_tr_b16 v[116:117], v14 offset:14336
    v_mfma_f32_16x16x32_bf16 v[76:79], v[84:87], v[96:99], v[76:79]
    ds_read_b64_tr_b16 v[118:119], v14 offset:14848
    s_waitcnt vmcnt(1)
    s_barrier
    s_waitcnt lgkmcnt(5)
    v_mfma_f32_16x16x32_bf16 v[56:59], v[108:111], v[100:103], v[56:59]
    ds_read_b128 v[80:83], v9 offset:57344
    ds_read_b64_tr_b16 v[88:89], v14 offset:24576
    s_waitcnt lgkmcnt(6)
    v_mfma_f32_16x16x32_bf16 v[60:63], v[108:111], v[104:107], v[60:63]
    ds_read_b64_tr_b16 v[90:91], v14 offset:25088
    s_waitcnt lgkmcnt(5)
    v_mfma_f32_16x16x32_bf16 v[64:67], v[112:115], v[100:103], v[64:67]
    ds_read_b128 v[84:87], v9 offset:59392
    v_mfma_f32_16x16x32_bf16 v[68:71], v[112:115], v[104:107], v[68:71]
    ds_read_b64_tr_b16 v[92:93], v14 offset:25600
    ds_read_b64_tr_b16 v[94:95], v14 offset:26112
    s_waitcnt lgkmcnt(6)
    v_mfma_f32_16x16x32_bf16 v[72:75], v[100:103], v[116:119], v[72:75]
    ds_read_b64_tr_b16 v[96:97], v14 offset:26624
    v_mfma_f32_16x16x32_bf16 v[76:79], v[104:107], v[116:119], v[76:79]
    ds_read_b64_tr_b16 v[98:99], v14 offset:27136
    s_waitcnt vmcnt(0)
    v_cmp_ne_u32 vcc, 0, v125
    s_and_b64 s[66:67], vcc, s[68:69]
    s_cmp_eq_u64 s[66:67], s[68:69]
    s_cselect_b32 s82, 1, 0
    s_cbranch_scc1 L_early
    buffer_load_dword v125, v5, s[44:47], s76 offen sc1
L_early:
    s_waitcnt lgkmcnt(5)
    v_mfma_f32_16x16x32_bf16 v[56:59], v[88:91], v[80:83], v[56:59]
    ds_read_b128 v[100:103], v10 offset:57344
    ds_read_b64_tr_b16 v[108:109], v14 offset:36864
    s_waitcnt lgkmcnt(6)
    v_mfma_f32_16x16x32_bf16 v[60:63], v[88:91], v[84:87], v[60:63]
    ds_read_b64_tr_b16 v[110:111], v14 offset:37376
    s_cmp_lg_u32 s82, 1
    s_cbranch_scc1 L_ef2
    buffer_load_dwordx4 v[24:27], v158, s[44:47], s81 offen sc1
L_ef2:
    s_waitcnt lgkmcnt(5)
    v_mfma_f32_16x16x32_bf16 v[64:67], v[92:95], v[80:83], v[64:67]
    ds_read_b128 v[104:107], v10 offset:59392
    s_cmp_lg_u32 s82, 1
    s_cbranch_scc1 L_ef3
    s_add_u32 m0, s64, 0
    s_add_u32 s3, s79, 4194304
    buffer_load_dwordx4 v158, s[44:47], s3 offen sc1 lds
L_ef3:
    v_mfma_f32_16x16x32_bf16 v[68:71], v[92:95], v[84:87], v[68:71]
    ds_read_b64_tr_b16 v[112:113], v14 offset:37888
    ds_read_b64_tr_b16 v[114:115], v14 offset:38400
    s_waitcnt lgkmcnt(6)
    v_mfma_f32_16x16x32_bf16 v[72:75], v[80:83], v[96:99], v[72:75]
    ds_read_b64_tr_b16 v[116:117], v14 offset:38912
    s_cmp_lg_u32 s82, 1
    s_cbranch_scc1 L_ef4
    s_mul_i32 s10, s28, 1040
    s_add_u32 m0, s10, 65536
    s_add_u32 s3, s79, 8388608
    buffer_load_dwordx4 v158, s[44:47], s3 offen sc1 lds
L_ef4:
    v_mfma_f32_16x16x32_bf16 v[76:79], v[84:87], v[96:99], v[76:79]
    ds_read_b64_tr_b16 v[118:119], v14 offset:39424
    s_cmp_lg_u32 s82, 1
    s_cbranch_scc1 L_ef5
    s_add_u32 m0, s64, 8192
    s_add_u32 s3, s79, 4210688
    buffer_load_dwordx4 v158, s[44:47], s3 offen sc1 lds
L_ef5:
    s_waitcnt lgkmcnt(5)
    v_mfma_f32_16x16x32_bf16 v[56:59], v[108:111], v[100:103], v[56:59]
    s_waitcnt lgkmcnt(4)
    v_mfma_f32_16x16x32_bf16 v[60:63], v[108:111], v[104:107], v[60:63]
    s_cmp_lg_u32 s82, 1
    s_cbranch_scc1 L_ef6
    s_mul_i32 s10, s28, 1040
    s_add_u32 m0, s10, 73856
    s_add_u32 s3, s79, 8404992
    buffer_load_dwordx4 v158, s[44:47], s3 offen sc1 lds
L_ef6:
    s_waitcnt lgkmcnt(2)
    v_mfma_f32_16x16x32_bf16 v[64:67], v[112:115], v[100:103], v[64:67]
    v_mfma_f32_16x16x32_bf16 v[68:71], v[112:115], v[104:107], v[68:71]
    s_waitcnt lgkmcnt(0)
    v_mfma_f32_16x16x32_bf16 v[72:75], v[100:103], v[116:119], v[72:75]
    v_mfma_f32_16x16x32_bf16 v[76:79], v[104:107], v[116:119], v[76:79]
    s_add_u32 s29, s83, 1
    s_lshl_b32 s29, s29, 2
    s_and_b32 s10, s28, 3
    s_add_u32 s29, s29, s10
    s_lshl_b32 s29, s29, 12
    s_add_u32 s29, s29, 12582912
    v_mov_b32 v14, v158
    s_nop 3
    v_cvt_pk_bf16_f32 v166, v64, v65
    v_cvt_pk_bf16_f32 v167, v66, v67
    v_cvt_pk_bf16_f32 v168, v68, v69
    v_cvt_pk_bf16_f32 v169, v70, v71
    v_pk_mul_f32 v[56:57], v[56:57], s[30:31] op_sel:[0,1] op_sel_hi:[1,1]
    v_pk_mul_f32 v[58:59], v[58:59], s[30:31] op_sel:[0,1] op_sel_hi:[1,1]
    v_permlane16_swap_b32 v166, v168
    v_pk_mul_f32 v[60:61], v[60:61], s[30:31] op_sel:[0,1] op_sel_hi:[1,1]
    v_permlane16_swap_b32 v167, v169
    v_pk_mul_f32 v[62:63], v[62:63], s[30:31] op_sel:[0,1] op_sel_hi:[1,1]
    v_cvt_pk_bf16_f32 v244, v56, v57
    v_cvt_pk_bf16_f32 v245, v58, v59
    v_cvt_pk_bf16_f32 v246, v60, v61
    v_cvt_pk_bf16_f32 v247, v62, v63
    v_cvt_pk_bf16_f32 v240, v72, v73
    v_cvt_pk_bf16_f32 v241, v74, v75
    v_cvt_pk_bf16_f32 v242, v76, v77
    v_permlane16_swap_b32 v244, v246
    v_cvt_pk_bf16_f32 v243, v78, v79
    v_permlane16_swap_b32 v245, v247
    v_mov_b32 v172, v146
    v_mov_b32 v173, v146
    v_mfma_f32_32x32x16_bf16 v[224:239], v[166:169], v[244:247], v[176:191]
    v_mov_b32 v174, v146
    v_mov_b32 v175, v146
    v_permlane16_swap_b32 v240, v242
    v_permlane16_swap_b32 v241, v243
    s_nop 0
    v_permlane32_swap_b32 v240, v242
    v_permlane32_swap_b32 v241, v243
    s_nop 0
    v_permlane16_swap_b32 v240, v172
    v_permlane16_swap_b32 v241, v173
    v_permlane16_swap_b32 v242, v174
    v_permlane16_swap_b32 v243, v175
    s_nop 0
    s_cmp_ge_u32 s28, 4
    s_cbranch_scc1 L_noex
    ds_write_b128 v17, v[166:169]
    ds_write_b128 v17, v[172:175] offset:1040
L_noex:
    s_cmp_lg_u32 s82, 0
    s_cbranch_scc1 L_kvok
    s_waitcnt vmcnt(0)
    s_mov_b32 s65, 400000
L_chk7:
    v_cmp_ne_u32 vcc, 0, v125
    s_and_b64 s[66:67], vcc, s[68:69]
    s_cmp_eq_u64 s[66:67], s[68:69]
    s_cbranch_scc1 L_chk7_ok
    s_sub_u32 s65, s65, 1
    s_cbranch_scc1 L_chk7_ok
    buffer_load_dword v125, v5, s[44:47], s76 offen sc1
    s_waitcnt vmcnt(0)
    s_branch L_chk7
L_chk7_ok:
    buffer_load_dwordx4 v[24:27], v158, s[44:47], s81 offen sc1
    s_add_u32 m0, s64, 0
    s_add_u32 s3, s79, 4194304
    buffer_load_dwordx4 v158, s[44:47], s3 offen sc1 lds
    s_mul_i32 s10, s28, 1040
    s_add_u32 m0, s10, 65536
    s_add_u32 s3, s79, 8388608
    buffer_load_dwordx4 v158, s[44:47], s3 offen sc1 lds
    s_add_u32 m0, s64, 8192
    s_add_u32 s3, s79, 4210688
    buffer_load_dwordx4 v158, s[44:47], s3 offen sc1 lds
    s_mul_i32 s10, s28, 1040
    s_add_u32 m0, s10, 73856
    s_add_u32 s3, s79, 8404992
    buffer_load_dwordx4 v158, s[44:47], s3 offen sc1 lds
L_kvok:
    v_exp_f32 v224, v224
    v_exp_f32 v225, v225
    v_exp_f32 v226, v226
    v_exp_f32 v227, v227
    v_cvt_pk_bf16_f32 v224, v224, v225
    v_exp_f32 v228, v228
    v_exp_f32 v229, v229
    v_cvt_pk_bf16_f32 v225, v226, v227
    v_exp_f32 v230, v230
    v_exp_f32 v231, v231
    v_cvt_pk_bf16_f32 v226, v228, v229
    v_exp_f32 v232, v232
    v_exp_f32 v233, v233
    v_cvt_pk_bf16_f32 v227, v230, v231
    v_exp_f32 v234, v234
    v_exp_f32 v235, v235
    v_cvt_pk_bf16_f32 v228, v232, v233
    v_mfma_f32_32x32x16_bf16 v[208:223], v[240:243], v[224:227], 0
    v_exp_f32 v236, v236
    v_exp_f32 v237, v237
    v_cvt_pk_bf16_f32 v229, v234, v235
    v_exp_f32 v238, v238
    v_exp_f32 v239, v239
    v_cvt_pk_bf16_f32 v230, v236, v237
    s_waitcnt vmcnt(0) lgkmcnt(0)
    s_cmp_eq_u32 s75, 0
    s_cbranch_scc1 L_nohalo
    buffer_store_dwordx4 v[166:169], v164, s[44:47], s29 offen sc1
    buffer_store_dwordx4 v[172:175], v164, s[44:47], s29 offen offset:2048 sc1
L_nohalo:
    buffer_store_dwordx2 v[152:153], v165, s[44:47], s21 offen sc1
    s_barrier
    ds_read_b128 v[28:31], v4 offset:0
    v_and_b32 v2, 28, v5
    v_add_u32 v2, 148480, v2
    v_mov_b32 v3, 0
    ds_write_b32 v2, v3
    ds_read_b128 v[32:35], v4 offset:1024
    s_not_b64 exec, s[70:71]
    ds_read_b128 v[36:39], v7 offset:0
    ds_read_b128 v[40:43], v8 offset:0
    s_mov_b64 exec, -1
    ds_read_b128 v[248:251], v17
    ds_read_b128 v[252:255], v17 offset:1040
    s_waitcnt lgkmcnt(6)
    v_mfma_f32_32x32x16_bf16 v[92:107], v[28:31], v[24:27], 0
    buffer_store_dwordx4 v[160:163], v14, s[44:47], s90 offen sc1
    buffer_load_dword v9, v5, s[44:47], s91 offen sc1
    s_nop 9
    s_setprio 3
    v_exp_f32 v92, v92
    s_waitcnt lgkmcnt(0)
    v_mfma_f32_32x32x16_bf16 v[108:123], v[32:35], v[24:27], 0
    ds_read_b128 v[28:31], v4 offset:2048
    v_exp_f32 v93, v93
    v_exp_f32 v94, v94
    v_cvt_pk_bf16_f32 v52, v92, v93
    s_mov_b64 exec, 1
    buffer_store_dword v160, off, s[44:47], s101 sc1
    s_mov_b64 exec, -1
    s_add_u32 m0, s64, 16384
    s_add_u32 s3, s79, 4227072
    buffer_load_dwordx4 v14, s[44:47], s3 offen sc1 lds
    v_exp_f32 v95, v95
    v_exp_f32 v96, v96
    v_cvt_pk_bf16_f32 v53, v94, v95
    v_exp_f32 v97, v97
    s_not_b64 exec, s[70:71]
    ds_read_b128 v[44:47], v7 offset:1040
    ds_read_b128 v[48:51], v8 offset:1040
    s_mov_b64 exec, -1
    v_exp_f32 v98, v98
    v_cvt_pk_bf16_f32 v54, v96, v97
    v_exp_f32 v99, v99
    v_exp_f32 v100, v100
    v_cvt_pk_bf16_f32 v55, v98, v99
    v_exp_f32 v101, v101
    v_exp_f32 v102, v102
    v_exp_f32 v103, v103
    v_mfma_f32_32x32x16_bf16 v[76:91], v[36:39], v[52:55], 0
    s_mul_i32 s10, s28, 1040
    s_add_u32 m0, s10, 82176
    s_add_u32 s3, s79, 8421376
    buffer_load_dwordx4 v14, s[44:47], s3 offen sc1 lds
    v_cvt_pk_bf16_f32 v56, v100, v101
    v_exp_f32 v104, v104
    v_cvt_pk_bf16_f32 v57, v102, v103
    v_exp_f32 v105, v105
    v_exp_f32 v106, v106
    v_cvt_pk_bf16_f32 v58, v104, v105
    v_exp_f32 v107, v107
    v_exp_f32 v108, v108
    v_cvt_pk_bf16_f32 v59, v106, v107
    s_waitcnt lgkmcnt(0)
    v_mfma_f32_32x32x16_bf16 v[92:107], v[28:31], v[24:27], 0
    ds_read_b128 v[32:35], v4 offset:3072
    v_exp_f32 v109, v109
    v_exp_f32 v110, v110
    v_cvt_pk_bf16_f32 v52, v108, v109
    s_add_u32 m0, s64, 24576
    s_add_u32 s3, s79, 4243456
    buffer_load_dwordx4 v14, s[44:47], s3 offen sc1 lds
    v_exp_f32 v111, v111
    v_exp_f32 v112, v112
    v_cvt_pk_bf16_f32 v53, v110, v111
    v_exp_f32 v113, v113
    v_mfma_f32_32x32x16_bf16 v[76:91], v[40:43], v[56:59], v[76:91]
    s_not_b64 exec, s[70:71]
    ds_read_b128 v[36:39], v7 offset:2080
    ds_read_b128 v[40:43], v8 offset:2080
    s_mov_b64 exec, -1
    v_exp_f32 v114, v114
    v_cvt_pk_bf16_f32 v54, v112, v113
    v_exp_f32 v115, v115
    v_exp_f32 v116, v116
    v_cvt_pk_bf16_f32 v55, v114, v115
    v_exp_f32 v117, v117
    v_exp_f32 v118, v118
    v_exp_f32 v119, v119
    v_mfma_f32_32x32x16_bf16 v[76:91], v[44:47], v[52:55], v[76:91]
    s_mul_i32 s10, s28, 1040
    s_add_u32 m0, s10, 90496
    s_add_u32 s3, s79, 8437760
    buffer_load_dwordx4 v14, s[44:47], s3 offen sc1 lds
    v_cvt_pk_bf16_f32 v56, v116, v117
    v_exp_f32 v120, v120
    v_cvt_pk_bf16_f32 v57, v118, v119
    v_exp_f32 v121, v121
    v_exp_f32 v122, v122
    v_cvt_pk_bf16_f32 v58, v120, v121
    v_exp_f32 v123, v123
    s_cmp_lt_u32 s28, 4
    s_cbranch_scc0 L_pr8
    s_setprio 2
L_pr8:
    v_exp_f32 v92, v92
    v_cvt_pk_bf16_f32 v59, v122, v123
    s_waitcnt lgkmcnt(0)
    v_mfma_f32_32x32x16_bf16 v[108:123], v[32:35], v[24:27], 0
    ds_read_b128 v[28:31], v4 offset:4096
    v_exp_f32 v93, v93
    v_exp_f32 v94, v94
    v_cvt_pk_bf16_f32 v52, v92, v93
    v_exp_f32 v95, v95
    v_exp_f32 v96, v96
    v_cvt_pk_bf16_f32 v53, v94, v95
    v_exp_f32 v97, v97
    v_mfma_f32_32x32x16_bf16 v[76:91], v[48:51], v[56:59], v[76:91]
    s_not_b64 exec, s[70:71]
    ds_read_b128 v[44:47], v7 offset:3120
    ds_read_b128 v[48:51], v8 offset:3120
    s_mov_b64 exec, -1
    v_exp_f32 v98, v98
    v_cvt_pk_bf16_f32 v54, v96, v97
    v_exp_f32 v99, v99
    v_exp_f32 v100, v100
    v_cvt_pk_bf16_f32 v55, v98, v99
    v_exp_f32 v101, v101
    v_exp_f32 v102, v102
    v_exp_f32 v103, v103
    v_mfma_f32_32x32x16_bf16 v[76:91], v[36:39], v[52:55], v[76:91]
    v_cvt_pk_bf16_f32 v56, v100, v101
    v_exp_f32 v104, v104
    v_cvt_pk_bf16_f32 v57, v102, v103
    v_exp_f32 v105, v105
    v_exp_f32 v106, v106
    v_cvt_pk_bf16_f32 v58, v104, v105
    v_exp_f32 v107, v107
    s_waitcnt vmcnt(5)
    s_cmp_eq_u32 s75, 0
    s_cbranch_scc1 L_nohalo2
    s_and_b32 s10, s28, 3
    s_lshl_b32 s10, s10, 2
    s_add_u32 s3, s97, s10
    v_mov_b32 v3, 1
    s_mov_b64 exec, 1
    buffer_store_dword v3, off, s[44:47], s3 sc1
    s_mov_b64 exec, -1
L_nohalo2:
    v_exp_f32 v108, v108
    v_cvt_pk_bf16_f32 v59, v106, v107
    s_waitcnt lgkmcnt(0)
    v_mfma_f32_32x32x16_bf16 v[92:107], v[28:31], v[24:27], 0
    ds_read_b128 v[32:35], v4 offset:5120
    v_exp_f32 v109, v109
    v_exp_f32 v110, v110
    v_cvt_pk_bf16_f32 v52, v108, v109
    v_exp_f32 v111, v111
    v_exp_f32 v112, v112
    v_cvt_pk_bf16_f32 v53, v110, v111
    v_exp_f32 v113, v113
    v_mfma_f32_32x32x16_bf16 v[76:91], v[40:43], v[56:59], v[76:91]
    s_not_b64 exec, s[70:71]
    ds_read_b128 v[36:39], v7 offset:4160
    ds_read_b128 v[40:43], v8 offset:4160
    s_mov_b64 exec, -1
    v_exp_f32 v114, v114
    v_cvt_pk_bf16_f32 v54, v112, v113
    v_exp_f32 v115, v115
    v_exp_f32 v116, v116
    v_cvt_pk_bf16_f32 v55, v114, v115
    v_exp_f32 v117, v117
    v_exp_f32 v118, v118
    v_exp_f32 v119, v119
    v_mfma_f32_32x32x16_bf16 v[76:91], v[44:47], v[52:55], v[76:91]
    v_cvt_pk_bf16_f32 v56, v116, v117
    v_exp_f32 v120, v120
    v_cvt_pk_bf16_f32 v57, v118, v119
    v_exp_f32 v121, v121
    v_exp_f32 v122, v122
    v_cvt_pk_bf16_f32 v58, v120, v121
    v_exp_f32 v123, v123
    s_cmp_lt_u32 s28, 4
    s_cbranch_scc1 L_pr9
    s_setprio 2
L_pr9:
    v_exp_f32 v92, v92
    v_cvt_pk_bf16_f32 v59, v122, v123
    s_waitcnt lgkmcnt(0)
    v_mfma_f32_32x32x16_bf16 v[108:123], v[32:35], v[24:27], 0
    ds_read_b128 v[28:31], v4 offset:6144
    v_exp_f32 v93, v93
    v_exp_f32 v94, v94
    v_cvt_pk_bf16_f32 v52, v92, v93
    v_exp_f32 v95, v95
    v_exp_f32 v96, v96
    v_cvt_pk_bf16_f32 v53, v94, v95
    v_exp_f32 v97, v97
    v_mfma_f32_32x32x16_bf16 v[76:91], v[48:51], v[56:59], v[76:91]
    s_not_b64 exec, s[70:71]
    ds_read_b128 v[44:47], v7 offset:5200
    ds_read_b128 v[48:51], v8 offset:5200
    s_mov_b64 exec, -1
    v_exp_f32 v98, v98
    v_cvt_pk_bf16_f32 v54, v96, v97
    v_exp_f32 v99, v99
    v_exp_f32 v100, v100
    v_cvt_pk_bf16_f32 v55, v98, v99
    v_exp_f32 v101, v101
    v_exp_f32 v102, v102
    v_exp_f32 v103, v103
    v_mfma_f32_32x32x16_bf16 v[76:91], v[36:39], v[52:55], v[76:91]
    v_cvt_pk_bf16_f32 v56, v100, v101
    v_exp_f32 v104, v104
    v_cvt_pk_bf16_f32 v57, v102, v103
    v_exp_f32 v105, v105
    v_exp_f32 v106, v106
    v_cvt_pk_bf16_f32 v58, v104, v105
    v_exp_f32 v107, v107
    v_exp_f32 v108, v108
    v_cvt_pk_bf16_f32 v59, v106, v107
    s_waitcnt lgkmcnt(0)
    v_mfma_f32_32x32x16_bf16 v[92:107], v[28:31], v[24:27], 0
    ds_read_b128 v[32:35], v4 offset:7168
    v_exp_f32 v109, v109
    v_exp_f32 v110, v110
    v_cvt_pk_bf16_f32 v52, v108, v109
    v_exp_f32 v111, v111
    v_exp_f32 v112, v112
    v_cvt_pk_bf16_f32 v53, v110, v111
    v_exp_f32 v113, v113
    v_mfma_f32_32x32x16_bf16 v[76:91], v[40:43], v[56:59], v[76:91]
    s_not_b64 exec, s[70:71]
    ds_read_b128 v[36:39], v7 offset:6240
    ds_read_b128 v[40:43], v8 offset:6240
    s_mov_b64 exec, -1
    v_exp_f32 v114, v114
    v_cvt_pk_bf16_f32 v54, v112, v113
    v_exp_f32 v115, v115
    v_exp_f32 v116, v116
    v_cvt_pk_bf16_f32 v55, v114, v115
    v_exp_f32 v117, v117
    v_exp_f32 v118, v118
    v_exp_f32 v119, v119
    v_mfma_f32_32x32x16_bf16 v[76:91], v[44:47], v[52:55], v[76:91]
    v_cvt_pk_bf16_f32 v56, v116, v117
    v_exp_f32 v120, v120
    v_cvt_pk_bf16_f32 v57, v118, v119
    v_exp_f32 v121, v121
    v_exp_f32 v122, v122
    v_cvt_pk_bf16_f32 v58, v120, v121
    v_exp_f32 v123, v123
    s_cmp_lt_u32 s28, 4
    s_cbranch_scc0 L_pr10
    s_setprio 1
L_pr10:
    v_exp_f32 v92, v92
    v_cvt_pk_bf16_f32 v59, v122, v123
    s_waitcnt lgkmcnt(0)
    v_mfma_f32_32x32x16_bf16 v[108:123], v[32:35], v[24:27], 0
    ds_read_b128 v[28:31], v4 offset:8192
    v_exp_f32 v93, v93
    v_exp_f32 v94, v94
    v_cvt_pk_bf16_f32 v52, v92, v93
    v_exp_f32 v95, v95
    v_exp_f32 v96, v96
    v_cvt_pk_bf16_f32 v53, v94, v95
    v_exp_f32 v97, v97
    v_mfma_f32_32x32x16_bf16 v[76:91], v[48:51], v[56:59], v[76:91]
    s_not_b64 exec, s[70:71]
    ds_read_b128 v[44:47], v7 offset:7280
    ds_read_b128 v[48:51], v8 offset:7280
    s_mov_b64 exec, -1
    v_exp_f32 v98, v98
    v_cvt_pk_bf16_f32 v54, v96, v97
    v_exp_f32 v99, v99
    v_exp_f32 v100, v100
    v_cvt_pk_bf16_f32 v55, v98, v99
    v_exp_f32 v101, v101
    v_exp_f32 v102, v102
    v_exp_f32 v103, v103
    v_mfma_f32_32x32x16_bf16 v[76:91], v[36:39], v[52:55], v[76:91]
    v_cvt_pk_bf16_f32 v56, v100, v101
    v_exp_f32 v104, v104
    v_cvt_pk_bf16_f32 v57, v102, v103
    v_exp_f32 v105, v105
    v_exp_f32 v106, v106
    v_cvt_pk_bf16_f32 v58, v104, v105
    v_exp_f32 v107, v107
    s_cmp_lt_u32 s28, 4
    s_cbranch_scc1 L_pr11
    s_setprio 1
L_pr11:
    v_exp_f32 v108, v108
    v_cvt_pk_bf16_f32 v59, v106, v107
    s_waitcnt lgkmcnt(0)
    v_mfma_f32_32x32x16_bf16 v[92:107], v[28:31], v[24:27], 0
    ds_read_b128 v[32:35], v4 offset:9216
    v_exp_f32 v109, v109
    v_exp_f32 v110, v110
    v_cvt_pk_bf16_f32 v52, v108, v109
    v_exp_f32 v111, v111
    v_exp_f32 v112, v112
    v_cvt_pk_bf16_f32 v53, v110, v111
    v_exp_f32 v113, v113
    v_mfma_f32_32x32x16_bf16 v[76:91], v[40:43], v[56:59], v[76:91]
    s_not_b64 exec, s[70:71]
    ds_read_b128 v[36:39], v7 offset:8320
    ds_read_b128 v[40:43], v8 offset:8320
    s_mov_b64 exec, -1
    v_exp_f32 v114, v114
    v_cvt_pk_bf16_f32 v54, v112, v113
    v_exp_f32 v115, v115
    v_exp_f32 v116, v116
    v_cvt_pk_bf16_f32 v55, v114, v115
    v_exp_f32 v117, v117
    v_exp_f32 v118, v118
    v_exp_f32 v119, v119
    v_mfma_f32_32x32x16_bf16 v[76:91], v[44:47], v[52:55], v[76:91]
    v_cvt_pk_bf16_f32 v56, v116, v117
    v_exp_f32 v120, v120
    v_cvt_pk_bf16_f32 v57, v118, v119
    v_exp_f32 v121, v121
    v_exp_f32 v122, v122
    v_cvt_pk_bf16_f32 v58, v120, v121
    v_exp_f32 v123, v123
    v_exp_f32 v92, v92
    v_cvt_pk_bf16_f32 v59, v122, v123
    s_waitcnt lgkmcnt(0)
    v_mfma_f32_32x32x16_bf16 v[108:123], v[32:35], v[24:27], 0
    ds_read_b128 v[28:31], v4 offset:10240
    v_exp_f32 v93, v93
    v_exp_f32 v94, v94
    v_cvt_pk_bf16_f32 v52, v92, v93
    v_exp_f32 v95, v95
    v_exp_f32 v96, v96
    v_cvt_pk_bf16_f32 v53, v94, v95
    v_exp_f32 v97, v97
    v_mfma_f32_32x32x16_bf16 v[76:91], v[48:51], v[56:59], v[76:91]
    s_not_b64 exec, s[70:71]
    ds_read_b128 v[44:47], v7 offset:9360
    ds_read_b128 v[48:51], v8 offset:9360
    s_mov_b64 exec, -1
    v_exp_f32 v98, v98
    v_cvt_pk_bf16_f32 v54, v96, v97
    v_exp_f32 v99, v99
    v_exp_f32 v100, v100
    v_cvt_pk_bf16_f32 v55, v98, v99
    v_exp_f32 v101, v101
    v_exp_f32 v102, v102
    v_exp_f32 v103, v103
    v_mfma_f32_32x32x16_bf16 v[76:91], v[36:39], v[52:55], v[76:91]
    v_cvt_pk_bf16_f32 v56, v100, v101
    v_exp_f32 v104, v104
    v_cvt_pk_bf16_f32 v57, v102, v103
    v_exp_f32 v105, v105
    v_exp_f32 v106, v106
    v_cvt_pk_bf16_f32 v58, v104, v105
    v_exp_f32 v107, v107
    buffer_load_dword v125, v5, s[44:47], s76 offen sc1
    s_cmp_lt_u32 s28, 4
    s_cbranch_scc0 L_pr12
    s_setprio 0
L_pr12:
    v_exp_f32 v108, v108
    v_cvt_pk_bf16_f32 v59, v106, v107
    s_waitcnt lgkmcnt(0)
    v_mfma_f32_32x32x16_bf16 v[92:107], v[28:31], v[24:27], 0
    ds_read_b128 v[32:35], v4 offset:11264
    v_exp_f32 v109, v109
    v_exp_f32 v110, v110
    v_cvt_pk_bf16_f32 v52, v108, v109
    v_exp_f32 v111, v111
    v_exp_f32 v112, v112
    v_cvt_pk_bf16_f32 v53, v110, v111
    v_exp_f32 v113, v113
    v_mfma_f32_32x32x16_bf16 v[76:91], v[40:43], v[56:59], v[76:91]
    s_not_b64 exec, s[70:71]
    ds_read_b128 v[36:39], v7 offset:10400
    ds_read_b128 v[40:43], v8 offset:10400
    s_mov_b64 exec, -1
    v_exp_f32 v114, v114
    v_cvt_pk_bf16_f32 v54, v112, v113
    v_exp_f32 v115, v115
    v_exp_f32 v116, v116
    v_cvt_pk_bf16_f32 v55, v114, v115
    v_exp_f32 v117, v117
    v_exp_f32 v118, v118
    v_exp_f32 v119, v119
    v_mfma_f32_32x32x16_bf16 v[76:91], v[44:47], v[52:55], v[76:91]
    v_cvt_pk_bf16_f32 v56, v116, v117
    v_exp_f32 v120, v120
    v_cvt_pk_bf16_f32 v57, v118, v119
    v_exp_f32 v121, v121
    v_exp_f32 v122, v122
    v_cvt_pk_bf16_f32 v58, v120, v121
    v_exp_f32 v123, v123
    v_exp_f32 v92, v92
    v_cvt_pk_bf16_f32 v59, v122, v123
    s_waitcnt lgkmcnt(0)
    v_mfma_f32_32x32x16_bf16 v[108:123], v[32:35], v[24:27], 0
    ds_read_b128 v[28:31], v4 offset:12288
    v_exp_f32 v93, v93
    v_exp_f32 v94, v94
    v_cvt_pk_bf16_f32 v52, v92, v93
    v_exp_f32 v95, v95
    v_exp_f32 v96, v96
    v_cvt_pk_bf16_f32 v53, v94, v95
    v_exp_f32 v97, v97
    v_mfma_f32_32x32x16_bf16 v[76:91], v[48:51], v[56:59], v[76:91]
    s_not_b64 exec, s[70:71]
    ds_read_b128 v[44:47], v7 offset:11440
    ds_read_b128 v[48:51], v8 offset:11440
    s_mov_b64 exec, -1
    v_exp_f32 v98, v98
    v_cvt_pk_bf16_f32 v54, v96, v97
    v_exp_f32 v99, v99
    v_exp_f32 v100, v100
    v_cvt_pk_bf16_f32 v55, v98, v99
    v_exp_f32 v101, v101
    v_exp_f32 v102, v102
    v_exp_f32 v103, v103
    v_mfma_f32_32x32x16_bf16 v[76:91], v[36:39], v[52:55], v[76:91]
    v_cvt_pk_bf16_f32 v56, v100, v101
    v_exp_f32 v104, v104
    v_cvt_pk_bf16_f32 v57, v102, v103
    v_exp_f32 v105, v105
    v_exp_f32 v106, v106
    v_cvt_pk_bf16_f32 v58, v104, v105
    v_exp_f32 v107, v107
    s_cmp_lt_u32 s28, 4
    s_cbranch_scc1 L_pr13
    s_setprio 0
L_pr13:
    v_exp_f32 v108, v108
    v_cvt_pk_bf16_f32 v59, v106, v107
    s_waitcnt lgkmcnt(0)
    v_mfma_f32_32x32x16_bf16 v[92:107], v[28:31], v[24:27], 0
    ds_read_b128 v[32:35], v4 offset:13312
    v_exp_f32 v109, v109
    v_exp_f32 v110, v110
    v_cvt_pk_bf16_f32 v52, v108, v109
    v_exp_f32 v111, v111
    v_exp_f32 v112, v112
    v_cvt_pk_bf16_f32 v53, v110, v111
    v_exp_f32 v113, v113
    v_mfma_f32_32x32x16_bf16 v[76:91], v[40:43], v[56:59], v[76:91]
    s_not_b64 exec, s[70:71]
    ds_read_b128 v[36:39], v7 offset:12480
    ds_read_b128 v[40:43], v8 offset:12480
    s_mov_b64 exec, -1
    v_exp_f32 v114, v114
    v_cvt_pk_bf16_f32 v54, v112, v113
    v_exp_f32 v115, v115
    v_exp_f32 v116, v116
    v_cvt_pk_bf16_f32 v55, v114, v115
    v_exp_f32 v117, v117
    v_exp_f32 v118, v118
    v_exp_f32 v119, v119
    v_mfma_f32_32x32x16_bf16 v[76:91], v[44:47], v[52:55], v[76:91]
    v_cvt_pk_bf16_f32 v56, v116, v117
    v_exp_f32 v120, v120
    v_cvt_pk_bf16_f32 v57, v118, v119
    v_exp_f32 v121, v121
    v_exp_f32 v122, v122
    v_cvt_pk_bf16_f32 v58, v120, v121
    v_exp_f32 v123, v123
    s_waitcnt vmcnt(3)
    s_barrier
    s_cmp_lg_u32 s28, 0
    s_cbranch_scc1 L_nof45
    s_lshl_b32 s3, s2, 2
    s_lshr_b32 s12, s2, 5
    s_lshl_b32 s12, s12, 7
    s_add_u32 s3, s3, s12
    s_add_u32 s3, s3, 17874944
    s_lshl_b32 s12, s25, 6
    s_add_u32 s12, s12, s24
    s_lshl_b32 s12, s12, 2
    s_add_u32 s12, s12, 17876992
    v_mov_b32 v2, s3
    v_mov_b32 v3, 1
    v_writelane_b32 v2, s12, 1
    s_mov_b64 exec, 3
    buffer_store_dword v3, v2, s[44:47], 0 offen sc1
    s_mov_b64 exec, -1
L_nof45:
    s_mov_b32 s68, s88
    s_waitcnt vmcnt(0)
    s_mov_b32 s65, 400000
L_chk14:
    v_cmp_ne_u32 vcc, 0, v125
    s_and_b64 s[66:67], vcc, s[68:69]
    s_cmp_eq_u64 s[66:67], s[68:69]
    s_cbranch_scc1 L_chk14_ok
    s_sub_u32 s65, s65, 1
    s_cbranch_scc1 L_chk14_ok
    buffer_load_dword v125, v5, s[44:47], s76 offen sc1
    s_waitcnt vmcnt(0)
    s_branch L_chk14
L_chk14_ok:
    s_setprio 3
    v_exp_f32 v92, v92
    v_cvt_pk_bf16_f32 v59, v122, v123
    s_waitcnt lgkmcnt(0)
    v_mfma_f32_32x32x16_bf16 v[108:123], v[32:35], v[24:27], 0
    ds_read_b128 v[28:31], v4 offset:14336
    v_exp_f32 v93, v93
    v_exp_f32 v94, v94
    v_cvt_pk_bf16_f32 v52, v92, v93
    s_add_u32 m0, s64, 32768
    s_add_u32 s3, s80, 4194304
    buffer_load_dwordx4 v14, s[44:47], s3 offen sc1 lds
    v_exp_f32 v95, v95
    v_exp_f32 v96, v96
    v_cvt_pk_bf16_f32 v53, v94, v95
    v_exp_f32 v97, v97
    v_mfma_f32_32x32x16_bf16 v[76:91], v[48:51], v[56:59], v[76:91]
    s_not_b64 exec, s[70:71]
    ds_read_b128 v[44:47], v7 offset:13520
    ds_read_b128 v[48:51], v8 offset:13520
    s_mov_b64 exec, -1
    v_exp_f32 v98, v98
    v_cvt_pk_bf16_f32 v54, v96, v97
    v_exp_f32 v99, v99
    v_exp_f32 v100, v100
    v_cvt_pk_bf16_f32 v55, v98, v99
    v_exp_f32 v101, v101
    v_exp_f32 v102, v102
    v_exp_f32 v103, v103
    v_mfma_f32_32x32x16_bf16 v[76:91], v[36:39], v[52:55], v[76:91]
    s_mul_i32 s10, s28, 1040
    s_add_u32 m0, s10, 98816
    s_add_u32 s3, s80, 8388608
    buffer_load_dwordx4 v14, s[44:47], s3 offen sc1 lds
    v_cvt_pk_bf16_f32 v56, v100, v101
    v_exp_f32 v104, v104
    v_cvt_pk_bf16_f32 v57, v102, v103
    v_exp_f32 v105, v105
    v_exp_f32 v106, v106
    v_cvt_pk_bf16_f32 v58, v104, v105
    v_exp_f32 v107, v107
    buffer_load_dword v125, v5, s[44:47], s78 offen sc1
    v_exp_f32 v108, v108
    v_cvt_pk_bf16_f32 v59, v106, v107
    s_waitcnt lgkmcnt(0)
    v_mfma_f32_32x32x16_bf16 v[92:107], v[28:31], v[24:27], 0
    ds_read_b128 v[32:35], v4 offset:15360
    v_exp_f32 v109, v109
    v_exp_f32 v110, v110
    v_cvt_pk_bf16_f32 v52, v108, v109
    s_add_u32 m0, s64, 40960
    s_add_u32 s3, s80, 4210688
    buffer_load_dwordx4 v14, s[44:47], s3 offen sc1 lds
    v_exp_f32 v111, v111
    v_exp_f32 v112, v112
    v_cvt_pk_bf16_f32 v53, v110, v111
    v_exp_f32 v113, v113
    v_mfma_f32_32x32x16_bf16 v[76:91], v[40:43], v[56:59], v[76:91]
    s_not_b64 exec, s[70:71]
    ds_read_b128 v[36:39], v7 offset:14560
    ds_read_b128 v[40:43], v8 offset:14560
    s_mov_b64 exec, -1
    v_exp_f32 v114, v114
    v_cvt_pk_bf16_f32 v54, v112, v113
    v_exp_f32 v115, v115
    v_exp_f32 v116, v116
    v_cvt_pk_bf16_f32 v55, v114, v115
    v_exp_f32 v117, v117
    v_exp_f32 v118, v118
    v_exp_f32 v119, v119
    v_mfma_f32_32x32x16_bf16 v[76:91], v[44:47], v[52:55], v[76:91]
    s_mul_i32 s10, s28, 1040
    s_add_u32 m0, s10, 107136
    s_add_u32 s3, s80, 8404992
    buffer_load_dwordx4 v14, s[44:47], s3 offen sc1 lds
    v_cvt_pk_bf16_f32 v56, v116, v117
    v_exp_f32 v120, v120
    v_cvt_pk_bf16_f32 v57, v118, v119
    v_exp_f32 v121, v121
    v_exp_f32 v122, v122
    v_cvt_pk_bf16_f32 v58, v120, v121
    v_exp_f32 v123, v123
    s_cmp_lt_u32 s28, 4
    s_cbranch_scc0 L_pr15
    s_setprio 2
L_pr15:
    v_exp_f32 v92, v92
    v_cvt_pk_bf16_f32 v59, v122, v123
    s_waitcnt lgkmcnt(0)
    v_mfma_f32_32x32x16_bf16 v[108:123], v[32:35], v[24:27], 0
    ds_read_b128 v[28:31], v4 offset:16384
    v_exp_f32 v93, v93
    v_exp_f32 v94, v94
    v_cvt_pk_bf16_f32 v52, v92, v93
    s_add_u32 m0, s64, 49152
    s_add_u32 s3, s80, 4227072
    buffer_load_dwordx4 v14, s[44:47], s3 offen sc1 lds
    v_exp_f32 v95, v95
    v_exp_f32 v96, v96
    v_cvt_pk_bf16_f32 v53, v94, v95
    v_exp_f32 v97, v97
    v_mfma_f32_32x32x16_bf16 v[76:91], v[48:51], v[56:59], v[76:91]
    s_not_b64 exec, s[70:71]
    ds_read_b128 v[44:47], v7 offset:15600
    ds_read_b128 v[48:51], v8 offset:15600
    s_mov_b64 exec, -1
    v_exp_f32 v98, v98
    v_cvt_pk_bf16_f32 v54, v96, v97
    v_exp_f32 v99, v99
    v_exp_f32 v100, v100
    v_cvt_pk_bf16_f32 v55, v98, v99
    v_exp_f32 v101, v101
    v_exp_f32 v102, v102
    v_exp_f32 v103, v103
    v_mfma_f32_32x32x16_bf16 v[76:91], v[36:39], v[52:55], v[76:91]
    s_mul_i32 s10, s28, 1040
    s_add_u32 m0, s10, 115456
    s_add_u32 s3, s80, 8421376
    buffer_load_dwordx4 v14, s[44:47], s3 offen sc1 lds
    v_cvt_pk_bf16_f32 v56, v100, v101
    v_exp_f32 v104, v104
    v_cvt_pk_bf16_f32 v57, v102, v103
    v_exp_f32 v105, v105
    v_exp_f32 v106, v106
    v_cvt_pk_bf16_f32 v58, v104, v105
    v_exp_f32 v107, v107
    s_cmp_lt_u32 s28, 4
    s_cbranch_scc1 L_pr16
    s_setprio 2
L_pr16:
    v_exp_f32 v108, v108
    v_cvt_pk_bf16_f32 v59, v106, v107
    s_waitcnt lgkmcnt(0)
    v_mfma_f32_32x32x16_bf16 v[92:107], v[28:31], v[24:27], 0
    ds_read_b128 v[32:35], v4 offset:17408
    v_exp_f32 v109, v109
    v_exp_f32 v110, v110
    v_cvt_pk_bf16_f32 v52, v108, v109
    s_add_u32 m0, s64, 57344
    s_add_u32 s3, s80, 4243456
    buffer_load_dwordx4 v14, s[44:47], s3 offen sc1 lds
    v_exp_f32 v111, v111
    v_exp_f32 v112, v112
    v_cvt_pk_bf16_f32 v53, v110, v111
    v_exp_f32 v113, v113
    v_mfma_f32_32x32x16_bf16 v[76:91], v[40:43], v[56:59], v[76:91]
    s_not_b64 exec, s[70:71]
    ds_read_b128 v[36:39], v7 offset:16640
    ds_read_b128 v[40:43], v8 offset:16640
    s_mov_b64 exec, -1
    v_exp_f32 v114, v114
    v_cvt_pk_bf16_f32 v54, v112, v113
    v_exp_f32 v115, v115
    v_exp_f32 v116, v116
    v_cvt_pk_bf16_f32 v55, v114, v115
    v_exp_f32 v117, v117
    v_exp_f32 v118, v118
    v_exp_f32 v119, v119
    v_mfma_f32_32x32x16_bf16 v[76:91], v[44:47], v[52:55], v[76:91]
    s_mul_i32 s10, s28, 1040
    s_add_u32 m0, s10, 123776
    s_add_u32 s3, s80, 8437760
    buffer_load_dwordx4 v14, s[44:47], s3 offen sc1 lds
    v_cvt_pk_bf16_f32 v56, v116, v117
    v_exp_f32 v120, v120
    v_cvt_pk_bf16_f32 v57, v118, v119
    v_exp_f32 v121, v121
    v_exp_f32 v122, v122
    v_cvt_pk_bf16_f32 v58, v120, v121
    v_exp_f32 v123, v123
    s_cmp_eq_u32 s74, 0
    s_cbranch_scc1 L_nodefer
    s_lshl_b32 s68, 1, s96
    s_waitcnt vmcnt(6)
    s_mov_b32 s65, 400000
L_chk17:
    v_cmp_ne_u32 vcc, 0, v125
    s_and_b64 s[66:67], vcc, s[68:69]
    s_cmp_eq_u64 s[66:67], s[68:69]
    s_cbranch_scc1 L_chk17_ok
    s_sub_u32 s65, s65, 1
    s_cbranch_scc1 L_chk17_ok
    buffer_load_dword v125, v5, s[44:47], s78 offen sc1
    s_waitcnt vmcnt(0)
    s_branch L_chk17
L_chk17_ok:
    s_lshl_b32 s3, s83, 2
    s_add_u32 s3, s3, s28
    s_lshl_b32 s3, s3, 12
    s_add_u32 s3, s3, 12582912
    buffer_load_dwordx4 v[248:251], v14, s[44:47], s3 offen sc1
    buffer_load_dwordx4 v[252:255], v14, s[44:47], s3 offen offset:2048 sc1
L_nodefer:
    buffer_load_dword v9, v5, s[44:47], s91 offen sc1
    s_cmp_lt_u32 s28, 4
    s_cbranch_scc0 L_pr18
    s_setprio 1
L_pr18:
    v_exp_f32 v92, v92
    v_cvt_pk_bf16_f32 v59, v122, v123
    s_waitcnt lgkmcnt(0)
    v_mfma_f32_32x32x16_bf16 v[108:123], v[32:35], v[24:27], 0
    ds_read_b128 v[28:31], v4 offset:18432
    v_exp_f32 v93, v93
    v_exp_f32 v94, v94
    v_cvt_pk_bf16_f32 v52, v92, v93
    v_exp_f32 v95, v95
    v_exp_f32 v96, v96
    v_cvt_pk_bf16_f32 v53, v94, v95
    v_exp_f32 v97, v97
    v_mfma_f32_32x32x16_bf16 v[76:91], v[48:51], v[56:59], v[76:91]
    s_not_b64 exec, s[70:71]
    ds_read_b128 v[44:47], v7 offset:17680
    ds_read_b128 v[48:51], v8 offset:17680
    s_mov_b64 exec, -1
    v_exp_f32 v98, v98
    v_cvt_pk_bf16_f32 v54, v96, v97
    v_exp_f32 v99, v99
    v_exp_f32 v100, v100
    v_cvt_pk_bf16_f32 v55, v98, v99
    v_exp_f32 v101, v101
    v_exp_f32 v102, v102
    v_exp_f32 v103, v103
    v_mfma_f32_32x32x16_bf16 v[76:91], v[36:39], v[52:55], v[76:91]
    v_cvt_pk_bf16_f32 v56, v100, v101
    v_exp_f32 v104, v104
    v_cvt_pk_bf16_f32 v57, v102, v103
    v_exp_f32 v105, v105
    v_exp_f32 v106, v106
    v_cvt_pk_bf16_f32 v58, v104, v105
    v_exp_f32 v107, v107
    v_exp_f32 v108, v108
    v_cvt_pk_bf16_f32 v59, v106, v107
    s_waitcnt lgkmcnt(0)
    v_mfma_f32_32x32x16_bf16 v[92:107], v[28:31], v[24:27], 0
    ds_read_b128 v[32:35], v4 offset:19456
    v_exp_f32 v109, v109
    v_exp_f32 v110, v110
    v_cvt_pk_bf16_f32 v52, v108, v109
    v_exp_f32 v111, v111
    v_exp_f32 v112, v112
    v_cvt_pk_bf16_f32 v53, v110, v111
    v_exp_f32 v113, v113
    v_mfma_f32_32x32x16_bf16 v[76:91], v[40:43], v[56:59], v[76:91]
    s_not_b64 exec, s[70:71]
    ds_read_b128 v[36:39], v7 offset:18720
    ds_read_b128 v[40:43], v8 offset:18720
    s_mov_b64 exec, -1
    v_exp_f32 v114, v114
    v_cvt_pk_bf16_f32 v54, v112, v113
    v_exp_f32 v115, v115
    v_exp_f32 v116, v116
    v_cvt_pk_bf16_f32 v55, v114, v115
    v_exp_f32 v117, v117
    v_exp_f32 v118, v118
    v_exp_f32 v119, v119
    v_mfma_f32_32x32x16_bf16 v[76:91], v[44:47], v[52:55], v[76:91]
    v_cvt_pk_bf16_f32 v56, v116, v117
    v_exp_f32 v120, v120
    v_cvt_pk_bf16_f32 v57, v118, v119
    v_exp_f32 v121, v121
    v_exp_f32 v122, v122
    v_cvt_pk_bf16_f32 v58, v120, v121
    v_exp_f32 v123, v123
    s_cmp_lt_u32 s28, 4
    s_cbranch_scc1 L_pr19
    s_setprio 1
L_pr19:
    v_exp_f32 v92, v92
    v_cvt_pk_bf16_f32 v59, v122, v123
    s_waitcnt lgkmcnt(0)
    v_mfma_f32_32x32x16_bf16 v[108:123], v[32:35], v[24:27], 0
    ds_read_b128 v[28:31], v4 offset:20480
    v_exp_f32 v93, v93
    v_exp_f32 v94, v94
    v_cvt_pk_bf16_f32 v52, v92, v93
    v_exp_f32 v95, v95
    v_exp_f32 v96, v96
    v_cvt_pk_bf16_f32 v53, v94, v95
    v_exp_f32 v97, v97
    v_mfma_f32_32x32x16_bf16 v[76:91], v[48:51], v[56:59], v[76:91]
    s_not_b64 exec, s[70:71]
    ds_read_b128 v[44:47], v7 offset:19760
    ds_read_b128 v[48:51], v8 offset:19760
    s_mov_b64 exec, -1
    v_exp_f32 v98, v98
    v_cvt_pk_bf16_f32 v54, v96, v97
    v_exp_f32 v99, v99
    v_exp_f32 v100, v100
    v_cvt_pk_bf16_f32 v55, v98, v99
    v_exp_f32 v101, v101
    v_exp_f32 v102, v102
    v_exp_f32 v103, v103
    v_mfma_f32_32x32x16_bf16 v[76:91], v[36:39], v[52:55], v[76:91]
    v_cvt_pk_bf16_f32 v56, v100, v101
    v_exp_f32 v104, v104
    v_cvt_pk_bf16_f32 v57, v102, v103
    v_exp_f32 v105, v105
    v_exp_f32 v106, v106
    v_cvt_pk_bf16_f32 v58, v104, v105
    v_exp_f32 v107, v107
    s_waitcnt vmcnt(0)
    s_cmp_lt_u32 s28, 4
    s_cbranch_scc0 L_pr20
    s_setprio 0
L_pr20:
    v_exp_f32 v108, v108
    v_cvt_pk_bf16_f32 v59, v106, v107
    s_waitcnt lgkmcnt(0)
    v_mfma_f32_32x32x16_bf16 v[92:107], v[28:31], v[24:27], 0
    ds_read_b128 v[32:35], v4 offset:21504
    v_exp_f32 v109, v109
    v_exp_f32 v110, v110
    v_cvt_pk_bf16_f32 v52, v108, v109
    v_mfma_f32_32x32x16_bf16 v[128:143], v[248:251], v[244:247], v[192:207]
    v_exp_f32 v111, v111
    v_exp_f32 v112, v112
    v_cvt_pk_bf16_f32 v53, v110, v111
    v_exp_f32 v113, v113
    v_mfma_f32_32x32x16_bf16 v[76:91], v[40:43], v[56:59], v[76:91]
    s_not_b64 exec, s[70:71]
    ds_read_b128 v[36:39], v7 offset:20800
    ds_read_b128 v[40:43], v8 offset:20800
    s_mov_b64 exec, -1
    v_exp_f32 v114, v114
    v_cvt_pk_bf16_f32 v54, v112, v113
    v_exp_f32 v115, v115
    v_exp_f32 v116, v116
    v_cvt_pk_bf16_f32 v55, v114, v115
    v_exp_f32 v117, v117
    v_exp_f32 v118, v118
    v_exp_f32 v119, v119
    v_mfma_f32_32x32x16_bf16 v[76:91], v[44:47], v[52:55], v[76:91]
    v_cvt_pk_bf16_f32 v56, v116, v117
    v_exp_f32 v120, v120
    v_cvt_pk_bf16_f32 v57, v118, v119
    v_exp_f32 v121, v121
    v_exp_f32 v122, v122
    v_cvt_pk_bf16_f32 v58, v120, v121
    v_exp_f32 v136, v136
    v_exp_f32 v137, v137
    v_cvt_pk_bf16_f32 v231, v238, v239
    v_exp_f32 v123, v123
    s_cmp_lt_u32 s28, 4
    s_cbranch_scc1 L_pr21
    s_setprio 0
L_pr21:
    v_exp_f32 v92, v92
    v_cvt_pk_bf16_f32 v59, v122, v123
    s_waitcnt lgkmcnt(0)
    v_mfma_f32_32x32x16_bf16 v[108:123], v[32:35], v[24:27], 0
    ds_read_b128 v[28:31], v4 offset:22528
    v_exp_f32 v93, v93
    v_exp_f32 v94, v94
    v_cvt_pk_bf16_f32 v52, v92, v93
    v_exp_f32 v138, v138
    v_exp_f32 v139, v139
    v_cvt_pk_bf16_f32 v136, v136, v137
    v_exp_f32 v95, v95
    v_exp_f32 v96, v96
    v_cvt_pk_bf16_f32 v53, v94, v95
    v_mfma_f32_32x32x16_bf16 v[208:223], v[172:175], v[228:231], v[208:223]
    v_exp_f32 v97, v97
    v_mfma_f32_32x32x16_bf16 v[76:91], v[48:51], v[56:59], v[76:91]
    s_not_b64 exec, s[70:71]
    ds_read_b128 v[44:47], v7 offset:21840
    ds_read_b128 v[48:51], v8 offset:21840
    s_mov_b64 exec, -1
    v_exp_f32 v98, v98
    v_cvt_pk_bf16_f32 v54, v96, v97
    v_exp_f32 v140, v140
    v_exp_f32 v141, v141
    v_cvt_pk_bf16_f32 v137, v138, v139
    v_exp_f32 v99, v99
    v_exp_f32 v100, v100
    v_cvt_pk_bf16_f32 v55, v98, v99
    v_exp_f32 v142, v142
    v_exp_f32 v143, v143
    v_cvt_pk_bf16_f32 v138, v140, v141
    v_exp_f32 v101, v101
    v_exp_f32 v102, v102
    v_exp_f32 v103, v103
    v_mfma_f32_32x32x16_bf16 v[76:91], v[36:39], v[52:55], v[76:91]
    v_cvt_pk_bf16_f32 v56, v100, v101
    v_exp_f32 v104, v104
    v_cvt_pk_bf16_f32 v57, v102, v103
    v_cvt_pk_bf16_f32 v139, v142, v143
    v_exp_f32 v105, v105
    v_exp_f32 v106, v106
    v_cvt_pk_bf16_f32 v58, v104, v105
    v_mfma_f32_32x32x16_bf16 v[208:223], v[252:255], v[136:139], v[208:223]
    v_exp_f32 v107, v107
    s_barrier
    s_setprio 3
    v_exp_f32 v108, v108
    v_cvt_pk_bf16_f32 v59, v106, v107
    s_waitcnt lgkmcnt(0)
    v_mfma_f32_32x32x16_bf16 v[92:107], v[28:31], v[24:27], 0
    ds_read_b128 v[32:35], v4 offset:23552
    v_exp_f32 v109, v109
    v_exp_f32 v110, v110
    v_cvt_pk_bf16_f32 v52, v108, v109
    v_exp_f32 v111, v111
    v_exp_f32 v112, v112
    v_cvt_pk_bf16_f32 v53, v110, v111
    v_exp_f32 v113, v113
    v_mfma_f32_32x32x16_bf16 v[76:91], v[40:43], v[56:59], v[76:91]
    s_not_b64 exec, s[70:71]
    ds_read_b128 v[36:39], v7 offset:22880
    ds_read_b128 v[40:43], v8 offset:22880
    s_mov_b64 exec, -1
    v_exp_f32 v114, v114
    v_cvt_pk_bf16_f32 v54, v112, v113
    v_exp_f32 v115, v115
    v_exp_f32 v116, v116
    v_cvt_pk_bf16_f32 v55, v114, v115
    v_exp_f32 v117, v117
    v_exp_f32 v118, v118
    v_exp_f32 v119, v119
    v_mfma_f32_32x32x16_bf16 v[76:91], v[44:47], v[52:55], v[76:91]
    v_cvt_pk_bf16_f32 v56, v116, v117
    v_exp_f32 v120, v120
    v_cvt_pk_bf16_f32 v57, v118, v119
    v_subrev_u32 v16, 0x21800000, v216
    v_cmp_gt_u32 vcc, 0x3e000000, v16
    s_cmp_eq_u64 vcc, -1
    s_cbranch_scc0 L_fa
L_fa_done:
    v_exp_f32 v121, v121
    v_exp_f32 v122, v122
    v_cvt_pk_bf16_f32 v58, v120, v121
    v_rcp_f32 v16, v216
    v_exp_f32 v123, v123
    v_exp_f32 v92, v92
    v_cvt_pk_bf16_f32 v59, v122, v123
    s_waitcnt lgkmcnt(0)
    v_mfma_f32_32x32x16_bf16 v[108:123], v[32:35], v[24:27], 0
    ds_read_b128 v[28:31], v4 offset:24576
    v_exp_f32 v93, v93
    v_exp_f32 v94, v94
    v_cvt_pk_bf16_f32 v52, v92, v93
    v_pk_mul_f32 v[208:209], v[208:209], v[16:17] op_sel:[0,0] op_sel_hi:[1,0]
    v_pk_mul_f32 v[210:211], v[210:211], v[16:17] op_sel:[0,0] op_sel_hi:[1,0]
    v_exp_f32 v95, v95
    v_exp_f32 v96, v96
    v_cvt_pk_bf16_f32 v53, v94, v95
    v_pk_mul_f32 v[212:213], v[212:213], v[16:17] op_sel:[0,0] op_sel_hi:[1,0]
    v_pk_mul_f32 v[214:215], v[214:215], v[16:17] op_sel:[0,0] op_sel_hi:[1,0]
    v_exp_f32 v97, v97
    v_mfma_f32_32x32x16_bf16 v[76:91], v[48:51], v[56:59], v[76:91]
    s_not_b64 exec, s[70:71]
    ds_read_b128 v[44:47], v7 offset:23920
    ds_read_b128 v[48:51], v8 offset:23920
    s_mov_b64 exec, -1
    v_exp_f32 v98, v98
    v_cvt_pk_bf16_f32 v54, v96, v97
    v_cvt_pk_bf16_f32 v208, v208, v209
    v_cvt_pk_bf16_f32 v209, v210, v211
    v_add_u32 v16, s93, v4
    v_exp_f32 v99, v99
    v_exp_f32 v100, v100
    v_cvt_pk_bf16_f32 v55, v98, v99
    v_cvt_pk_bf16_f32 v210, v212, v213
    v_cvt_pk_bf16_f32 v211, v214, v215
    v_lshrrev_b32 v16, 10, v16
    v_exp_f32 v101, v101
    v_exp_f32 v102, v102
    v_exp_f32 v103, v103
    v_mfma_f32_32x32x16_bf16 v[76:91], v[36:39], v[52:55], v[76:91]
    v_cvt_pk_bf16_f32 v56, v100, v101
    v_exp_f32 v104, v104
    v_cvt_pk_bf16_f32 v57, v102, v103
    v_lshl_add_u32 v16, v16, 7, v4
    s_lshl_b32 s3, s72, 6
    s_add_u32 s3, s3, s73
    s_lshl_b32 s3, s3, 11
    s_add_u32 s3, s3, 20971520
    buffer_store_dwordx4 v[208:211], v16, s[44:47], s3 offen sc1
    v_exp_f32 v105, v105
    v_exp_f32 v106, v106
    v_cvt_pk_bf16_f32 v58, v104, v105
    v_exp_f32 v107, v107
    s_cmp_lt_u32 s28, 4
    s_cbranch_scc0 L_pr22
    s_setprio 2
L_pr22:
    v_exp_f32 v108, v108
    v_cvt_pk_bf16_f32 v59, v106, v107
    s_waitcnt lgkmcnt(0)
    v_mfma_f32_32x32x16_bf16 v[92:107], v[28:31], v[24:27], 0
    ds_read_b128 v[32:35], v4 offset:25600
    v_exp_f32 v109, v109
    v_exp_f32 v110, v110
    v_cvt_pk_bf16_f32 v52, v108, v109
    v_exp_f32 v111, v111
    v_exp_f32 v112, v112
    v_cvt_pk_bf16_f32 v53, v110, v111
    v_exp_f32 v113, v113
    v_mfma_f32_32x32x16_bf16 v[76:91], v[40:43], v[56:59], v[76:91]
    s_not_b64 exec, s[70:71]
    ds_read_b128 v[36:39], v7 offset:24960
    ds_read_b128 v[40:43], v8 offset:24960
    s_mov_b64 exec, -1
    v_exp_f32 v114, v114
    v_cvt_pk_bf16_f32 v54, v112, v113
    v_exp_f32 v115, v115
    v_exp_f32 v116, v116
    v_cvt_pk_bf16_f32 v55, v114, v115
    v_exp_f32 v117, v117
    v_exp_f32 v118, v118
    v_exp_f32 v119, v119
    v_mfma_f32_32x32x16_bf16 v[76:91], v[44:47], v[52:55], v[76:91]
    v_cvt_pk_bf16_f32 v56, v116, v117
    v_exp_f32 v120, v120
    v_cvt_pk_bf16_f32 v57, v118, v119
    v_exp_f32 v121, v121
    v_exp_f32 v122, v122
    v_cvt_pk_bf16_f32 v58, v120, v121
    v_exp_f32 v123, v123
    s_cmp_lt_u32 s28, 4
    s_cbranch_scc1 L_pr23
    s_setprio 2
L_pr23:
    v_exp_f32 v92, v92
    v_cvt_pk_bf16_f32 v59, v122, v123
    s_waitcnt lgkmcnt(0)
    v_mfma_f32_32x32x16_bf16 v[108:123], v[32:35], v[24:27], 0
    ds_read_b128 v[28:31], v4 offset:26624
    v_exp_f32 v93, v93
    v_exp_f32 v94, v94
    v_cvt_pk_bf16_f32 v52, v92, v93
    v_exp_f32 v95, v95
    v_exp_f32 v96, v96
    v_cvt_pk_bf16_f32 v53, v94, v95
    v_exp_f32 v97, v97
    v_mfma_f32_32x32x16_bf16 v[76:91], v[48:51], v[56:59], v[76:91]
    s_not_b64 exec, s[70:71]
    ds_read_b128 v[44:47], v7 offset:26000
    ds_read_b128 v[48:51], v8 offset:26000
    s_mov_b64 exec, -1
    v_exp_f32 v98, v98
    v_cvt_pk_bf16_f32 v54, v96, v97
    v_exp_f32 v99, v99
    v_exp_f32 v100, v100
    v_cvt_pk_bf16_f32 v55, v98, v99
    v_exp_f32 v101, v101
    v_exp_f32 v102, v102
    v_exp_f32 v103, v103
    v_mfma_f32_32x32x16_bf16 v[76:91], v[36:39], v[52:55], v[76:91]
    v_cvt_pk_bf16_f32 v56, v100, v101
    v_exp_f32 v104, v104
    v_cvt_pk_bf16_f32 v57, v102, v103
    v_exp_f32 v105, v105
    v_exp_f32 v106, v106
    v_cvt_pk_bf16_f32 v58, v104, v105
    v_exp_f32 v107, v107
    s_waitcnt vmcnt(0)
    s_lshl_b32 s3, s72, 8
    s_lshl_b32 s10, s73, 2
    s_add_u32 s3, s3, s10
    s_add_u32 s3, s3, 17842176
    v_mov_b32 v3, 1
    s_mov_b64 exec, 1
    buffer_store_dword v3, off, s[44:47], s3 sc1
    s_mov_b64 exec, -1
    s_cmp_lt_u32 s28, 4
    s_cbranch_scc0 L_pr24
    s_setprio 1
L_pr24:
    v_exp_f32 v108, v108
    v_cvt_pk_bf16_f32 v59, v106, v107
    s_waitcnt lgkmcnt(0)
    v_mfma_f32_32x32x16_bf16 v[92:107], v[28:31], v[24:27], 0
    ds_read_b128 v[32:35], v4 offset:27648
    v_exp_f32 v109, v109
    v_exp_f32 v110, v110
    v_cvt_pk_bf16_f32 v52, v108, v109
    v_exp_f32 v111, v111
    v_exp_f32 v112, v112
    v_cvt_pk_bf16_f32 v53, v110, v111
    v_exp_f32 v113, v113
    v_mfma_f32_32x32x16_bf16 v[76:91], v[40:43], v[56:59], v[76:91]
    s_not_b64 exec, s[70:71]
    ds_read_b128 v[36:39], v7 offset:27040
    ds_read_b128 v[40:43], v8 offset:27040
    s_mov_b64 exec, -1
    v_exp_f32 v114, v114
    v_cvt_pk_bf16_f32 v54, v112, v113
    v_exp_f32 v115, v115
    v_exp_f32 v116, v116
    v_cvt_pk_bf16_f32 v55, v114, v115
    v_exp_f32 v117, v117
    v_exp_f32 v118, v118
    v_exp_f32 v119, v119
    v_mfma_f32_32x32x16_bf16 v[76:91], v[44:47], v[52:55], v[76:91]
    v_cvt_pk_bf16_f32 v56, v116, v117
    v_exp_f32 v120, v120
    v_cvt_pk_bf16_f32 v57, v118, v119
    v_exp_f32 v121, v121
    v_exp_f32 v122, v122
    v_cvt_pk_bf16_f32 v58, v120, v121
    v_exp_f32 v123, v123
    buffer_load_dword v124, v22, s[44:47], s89 offen sc1
    v_exp_f32 v92, v92
    v_cvt_pk_bf16_f32 v59, v122, v123
    s_waitcnt lgkmcnt(0)
    v_mfma_f32_32x32x16_bf16 v[108:123], v[32:35], v[24:27], 0
    ds_read_b128 v[28:31], v4 offset:28672
    v_exp_f32 v93, v93
    v_exp_f32 v94, v94
    v_cvt_pk_bf16_f32 v52, v92, v93
    v_exp_f32 v95, v95
    v_exp_f32 v96, v96
    v_cvt_pk_bf16_f32 v53, v94, v95
    v_exp_f32 v97, v97
    v_mfma_f32_32x32x16_bf16 v[76:91], v[48:51], v[56:59], v[76:91]
    s_not_b64 exec, s[70:71]
    ds_read_b128 v[44:47], v7 offset:28080
    ds_read_b128 v[48:51], v8 offset:28080
    s_mov_b64 exec, -1
    v_exp_f32 v98, v98
    v_cvt_pk_bf16_f32 v54, v96, v97
    v_exp_f32 v99, v99
    v_exp_f32 v100, v100
    v_cvt_pk_bf16_f32 v55, v98, v99
    v_exp_f32 v101, v101
    v_exp_f32 v102, v102
    v_exp_f32 v103, v103
    v_mfma_f32_32x32x16_bf16 v[76:91], v[36:39], v[52:55], v[76:91]
    v_cvt_pk_bf16_f32 v56, v100, v101
    v_exp_f32 v104, v104
    v_cvt_pk_bf16_f32 v57, v102, v103
    v_exp_f32 v105, v105
    v_exp_f32 v106, v106
    v_cvt_pk_bf16_f32 v58, v104, v105
    v_exp_f32 v107, v107
    s_cmp_lt_u32 s28, 4
    s_cbranch_scc1 L_pr25
    s_setprio 1
L_pr25:
    v_exp_f32 v108, v108
    v_cvt_pk_bf16_f32 v59, v106, v107
    s_waitcnt lgkmcnt(0)
    v_mfma_f32_32x32x16_bf16 v[92:107], v[28:31], v[24:27], 0
    ds_read_b128 v[32:35], v4 offset:29696
    v_exp_f32 v109, v109
    v_exp_f32 v110, v110
    v_cvt_pk_bf16_f32 v52, v108, v109
    v_exp_f32 v111, v111
    v_exp_f32 v112, v112
    v_cvt_pk_bf16_f32 v53, v110, v111
    v_exp_f32 v113, v113
    v_mfma_f32_32x32x16_bf16 v[76:91], v[40:43], v[56:59], v[76:91]
    s_not_b64 exec, s[70:71]
    ds_read_b128 v[36:39], v7 offset:29120
    ds_read_b128 v[40:43], v8 offset:29120
    s_mov_b64 exec, -1
    v_exp_f32 v114, v114
    v_cvt_pk_bf16_f32 v54, v112, v113
    v_exp_f32 v115, v115
    v_exp_f32 v116, v116
    v_cvt_pk_bf16_f32 v55, v114, v115
    v_exp_f32 v117, v117
    v_exp_f32 v118, v118
    v_exp_f32 v119, v119
    v_mfma_f32_32x32x16_bf16 v[76:91], v[44:47], v[52:55], v[76:91]
    v_cvt_pk_bf16_f32 v56, v116, v117
    v_exp_f32 v120, v120
    v_cvt_pk_bf16_f32 v57, v118, v119
    v_exp_f32 v121, v121
    v_exp_f32 v122, v122
    v_cvt_pk_bf16_f32 v58, v120, v121
    v_exp_f32 v123, v123
    s_cmp_lt_u32 s28, 4
    s_cbranch_scc0 L_pr26
    s_setprio 0
L_pr26:
    v_exp_f32 v92, v92
    v_cvt_pk_bf16_f32 v59, v122, v123
    s_waitcnt lgkmcnt(0)
    v_mfma_f32_32x32x16_bf16 v[108:123], v[32:35], v[24:27], 0
    ds_read_b128 v[28:31], v4 offset:30720
    v_exp_f32 v93, v93
    v_exp_f32 v94, v94
    v_cvt_pk_bf16_f32 v52, v92, v93
    v_exp_f32 v95, v95
    v_exp_f32 v96, v96
    v_cvt_pk_bf16_f32 v53, v94, v95
    v_exp_f32 v97, v97
    v_mfma_f32_32x32x16_bf16 v[76:91], v[48:51], v[56:59], v[76:91]
    s_not_b64 exec, s[70:71]
    ds_read_b128 v[44:47], v7 offset:30160
    ds_read_b128 v[48:51], v8 offset:30160
    s_mov_b64 exec, -1
    v_exp_f32 v98, v98
    v_cvt_pk_bf16_f32 v54, v96, v97
    v_exp_f32 v99, v99
    v_exp_f32 v100, v100
    v_cvt_pk_bf16_f32 v55, v98, v99
    v_exp_f32 v101, v101
    v_exp_f32 v102, v102
    v_exp_f32 v103, v103
    v_mfma_f32_32x32x16_bf16 v[76:91], v[36:39], v[52:55], v[76:91]
    v_cvt_pk_bf16_f32 v56, v100, v101
    v_exp_f32 v104, v104
    v_cvt_pk_bf16_f32 v57, v102, v103
    v_exp_f32 v105, v105
    v_exp_f32 v106, v106
    v_cvt_pk_bf16_f32 v58, v104, v105
    v_exp_f32 v107, v107
    s_waitcnt vmcnt(0)
    s_mov_b32 s65, 400000
L_wf:
    v_cmp_ne_u32 vcc, 0, v124
    s_cmp_eq_u64 vcc, -1
    s_cbranch_scc1 L_wf_ok
    s_sub_u32 s65, s65, 1
    s_cbranch_scc1 L_wf_ok
    buffer_load_dword v124, v22, s[44:47], s89 offen sc1
    s_waitcnt vmcnt(0)
    s_branch L_wf
L_wf_ok:
    s_cmp_lt_u32 s28, 4
    s_cbranch_scc1 L_pr27
    s_setprio 0
L_pr27:
    v_exp_f32 v108, v108
    v_cvt_pk_bf16_f32 v59, v106, v107
    s_waitcnt lgkmcnt(0)
    v_mfma_f32_32x32x16_bf16 v[92:107], v[28:31], v[24:27], 0
    ds_read_b128 v[32:35], v4 offset:31744
    v_exp_f32 v109, v109
    v_exp_f32 v110, v110
    v_cvt_pk_bf16_f32 v52, v108, v109
    s_add_u32 s29, s87, 24576
    buffer_load_dwordx4 v[128:131], v14, s[44:47], s29 offen sc1
    v_exp_f32 v111, v111
    v_exp_f32 v112, v112
    v_cvt_pk_bf16_f32 v53, v110, v111
    v_exp_f32 v113, v113
    v_mfma_f32_32x32x16_bf16 v[76:91], v[40:43], v[56:59], v[76:91]
    s_not_b64 exec, s[70:71]
    ds_read_b128 v[36:39], v7 offset:31200
    ds_read_b128 v[40:43], v8 offset:31200
    s_mov_b64 exec, -1
    v_exp_f32 v114, v114
    v_cvt_pk_bf16_f32 v54, v112, v113
    v_exp_f32 v115, v115
    v_exp_f32 v116, v116
    v_cvt_pk_bf16_f32 v55, v114, v115
    v_exp_f32 v117, v117
    v_exp_f32 v118, v118
    v_exp_f32 v119, v119
    v_mfma_f32_32x32x16_bf16 v[76:91], v[44:47], v[52:55], v[76:91]
    v_cvt_pk_bf16_f32 v56, v116, v117
    v_exp_f32 v120, v120
    v_cvt_pk_bf16_f32 v57, v118, v119
    v_exp_f32 v121, v121
    v_exp_f32 v122, v122
    v_cvt_pk_bf16_f32 v58, v120, v121
    v_exp_f32 v123, v123
    s_barrier
    s_setprio 3
    v_exp_f32 v92, v92
    v_cvt_pk_bf16_f32 v59, v122, v123
    s_waitcnt lgkmcnt(0)
    v_mfma_f32_32x32x16_bf16 v[108:123], v[32:35], v[24:27], 0
    ds_read_b128 v[28:31], v4 offset:32768
    v_exp_f32 v93, v93
    v_exp_f32 v94, v94
    v_cvt_pk_bf16_f32 v52, v92, v93
    s_add_u32 s29, s87, 26624
    buffer_load_dwordx4 v[132:135], v14, s[44:47], s29 offen sc1
    v_exp_f32 v95, v95
    v_exp_f32 v96, v96
    v_cvt_pk_bf16_f32 v53, v94, v95
    v_exp_f32 v97, v97
    v_mfma_f32_32x32x16_bf16 v[76:91], v[48:51], v[56:59], v[76:91]
    s_not_b64 exec, s[70:71]
    ds_read_b128 v[44:47], v7 offset:32240
    ds_read_b128 v[48:51], v8 offset:32240
    s_mov_b64 exec, -1
    v_exp_f32 v98, v98
    v_cvt_pk_bf16_f32 v54, v96, v97
    v_exp_f32 v99, v99
    v_exp_f32 v100, v100
    v_cvt_pk_bf16_f32 v55, v98, v99
    v_exp_f32 v101, v101
    v_exp_f32 v102, v102
    v_exp_f32 v103, v103
    v_mfma_f32_32x32x16_bf16 v[76:91], v[36:39], v[52:55], v[76:91]
    v_cvt_pk_bf16_f32 v56, v100, v101
    v_exp_f32 v104, v104
    v_cvt_pk_bf16_f32 v57, v102, v103
    v_exp_f32 v105, v105
    v_exp_f32 v106, v106
    v_cvt_pk_bf16_f32 v58, v104, v105
    v_exp_f32 v107, v107
    v_exp_f32 v108, v108
    v_cvt_pk_bf16_f32 v59, v106, v107
    s_waitcnt lgkmcnt(0)
    v_mfma_f32_32x32x16_bf16 v[92:107], v[28:31], v[24:27], 0
    ds_read_b128 v[32:35], v4 offset:33792
    v_exp_f32 v109, v109
    v_exp_f32 v110, v110
    v_cvt_pk_bf16_f32 v52, v108, v109
    s_add_u32 s29, s87, 28672
    buffer_load_dwordx4 v[136:139], v14, s[44:47], s29 offen sc1
    v_exp_f32 v111, v111
    v_exp_f32 v112, v112
    v_cvt_pk_bf16_f32 v53, v110, v111
    v_exp_f32 v113, v113
    v_mfma_f32_32x32x16_bf16 v[76:91], v[40:43], v[56:59], v[76:91]
    s_not_b64 exec, s[70:71]
    ds_read_b128 v[36:39], v7 offset:33280
    ds_read_b128 v[40:43], v8 offset:33280
    s_mov_b64 exec, -1
    v_exp_f32 v114, v114
    v_cvt_pk_bf16_f32 v54, v112, v113
    v_exp_f32 v115, v115
    v_exp_f32 v116, v116
    v_cvt_pk_bf16_f32 v55, v114, v115
    v_exp_f32 v117, v117
    v_exp_f32 v118, v118
    v_exp_f32 v119, v119
    v_mfma_f32_32x32x16_bf16 v[76:91], v[44:47], v[52:55], v[76:91]
    v_cvt_pk_bf16_f32 v56, v116, v117
    v_exp_f32 v120, v120
    v_cvt_pk_bf16_f32 v57, v118, v119
    v_exp_f32 v121, v121
    v_exp_f32 v122, v122
    v_cvt_pk_bf16_f32 v58, v120, v121
    v_exp_f32 v123, v123
    v_exp_f32 v92, v92
    v_cvt_pk_bf16_f32 v59, v122, v123
    s_waitcnt lgkmcnt(0)
    v_mfma_f32_32x32x16_bf16 v[108:123], v[32:35], v[24:27], 0
    ds_read_b128 v[28:31], v4 offset:34816
    v_exp_f32 v93, v93
    v_exp_f32 v94, v94
    v_cvt_pk_bf16_f32 v52, v92, v93
    s_add_u32 s29, s87, 30720
    buffer_load_dwordx4 v[140:143], v14, s[44:47], s29 offen sc1
    v_exp_f32 v95, v95
    v_exp_f32 v96, v96
    v_cvt_pk_bf16_f32 v53, v94, v95
    v_exp_f32 v97, v97
    v_mfma_f32_32x32x16_bf16 v[76:91], v[48:51], v[56:59], v[76:91]
    s_not_b64 exec, s[70:71]
    ds_read_b128 v[44:47], v7 offset:34320
    ds_read_b128 v[48:51], v8 offset:34320
    s_mov_b64 exec, -1
    v_exp_f32 v98, v98
    v_cvt_pk_bf16_f32 v54, v96, v97
    v_exp_f32 v99, v99
    v_exp_f32 v100, v100
    v_cvt_pk_bf16_f32 v55, v98, v99
    v_exp_f32 v101, v101
    v_exp_f32 v102, v102
    v_exp_f32 v103, v103
    v_mfma_f32_32x32x16_bf16 v[76:91], v[36:39], v[52:55], v[76:91]
    v_cvt_pk_bf16_f32 v56, v100, v101
    v_exp_f32 v104, v104
    v_cvt_pk_bf16_f32 v57, v102, v103
    v_exp_f32 v105, v105
    v_exp_f32 v106, v106
    v_cvt_pk_bf16_f32 v58, v104, v105
    v_exp_f32 v107, v107
    s_cmp_lt_u32 s28, 4
    s_cbranch_scc0 L_pr28
    s_setprio 2
L_pr28:
    v_exp_f32 v108, v108
    v_cvt_pk_bf16_f32 v59, v106, v107
    s_waitcnt lgkmcnt(0)
    v_mfma_f32_32x32x16_bf16 v[92:107], v[28:31], v[24:27], 0
    ds_read_b128 v[32:35], v4 offset:35840
    v_exp_f32 v109, v109
    v_exp_f32 v110, v110
    v_cvt_pk_bf16_f32 v52, v108, v109
    s_add_u32 s29, s87, 1050624
    buffer_load_dwordx4 v[144:147], v14, s[44:47], s29 offen sc1
    v_exp_f32 v111, v111
    v_exp_f32 v112, v112
    v_cvt_pk_bf16_f32 v53, v110, v111
    v_exp_f32 v113, v113
    v_mfma_f32_32x32x16_bf16 v[76:91], v[40:43], v[56:59], v[76:91]
    s_not_b64 exec, s[70:71]
    ds_read_b128 v[36:39], v7 offset:35360
    ds_read_b128 v[40:43], v8 offset:35360
    s_mov_b64 exec, -1
    v_exp_f32 v114, v114
    v_cvt_pk_bf16_f32 v54, v112, v113
    v_exp_f32 v115, v115
    v_exp_f32 v116, v116
    v_cvt_pk_bf16_f32 v55, v114, v115
    v_exp_f32 v117, v117
    v_exp_f32 v118, v118
    v_exp_f32 v119, v119
    v_mfma_f32_32x32x16_bf16 v[76:91], v[44:47], v[52:55], v[76:91]
    v_cvt_pk_bf16_f32 v56, v116, v117
    v_exp_f32 v120, v120
    v_cvt_pk_bf16_f32 v57, v118, v119
    v_exp_f32 v121, v121
    v_exp_f32 v122, v122
    v_cvt_pk_bf16_f32 v58, v120, v121
    v_exp_f32 v123, v123
    v_exp_f32 v92, v92
    v_cvt_pk_bf16_f32 v59, v122, v123
    s_waitcnt lgkmcnt(0)
    v_mfma_f32_32x32x16_bf16 v[108:123], v[32:35], v[24:27], 0
    ds_read_b128 v[28:31], v4 offset:36864
    v_exp_f32 v93, v93
    v_exp_f32 v94, v94
    v_cvt_pk_bf16_f32 v52, v92, v93
    s_add_u32 s29, s87, 1054720
    buffer_load_dwordx4 v[148:151], v14, s[44:47], s29 offen sc1
    v_exp_f32 v95, v95
    v_exp_f32 v96, v96
    v_cvt_pk_bf16_f32 v53, v94, v95
    v_exp_f32 v97, v97
    v_mfma_f32_32x32x16_bf16 v[76:91], v[48:51], v[56:59], v[76:91]
    s_not_b64 exec, s[70:71]
    ds_read_b128 v[44:47], v7 offset:36400
    ds_read_b128 v[48:51], v8 offset:36400
    s_mov_b64 exec, -1
    v_exp_f32 v98, v98
    v_cvt_pk_bf16_f32 v54, v96, v97
    v_exp_f32 v99, v99
    v_exp_f32 v100, v100
    v_cvt_pk_bf16_f32 v55, v98, v99
    v_exp_f32 v101, v101
    v_exp_f32 v102, v102
    v_exp_f32 v103, v103
    v_mfma_f32_32x32x16_bf16 v[76:91], v[36:39], v[52:55], v[76:91]
    v_cvt_pk_bf16_f32 v56, v100, v101
    v_exp_f32 v104, v104
    v_cvt_pk_bf16_f32 v57, v102, v103
    v_exp_f32 v105, v105
    v_exp_f32 v106, v106
    v_cvt_pk_bf16_f32 v58, v104, v105
    v_exp_f32 v107, v107
    s_cmp_lt_u32 s28, 4
    s_cbranch_scc1 L_pr29
    s_setprio 2
L_pr29:
    v_exp_f32 v108, v108
    v_cvt_pk_bf16_f32 v59, v106, v107
    s_waitcnt lgkmcnt(0)
    v_mfma_f32_32x32x16_bf16 v[92:107], v[28:31], v[24:27], 0
    ds_read_b128 v[32:35], v4 offset:37888
    v_exp_f32 v109, v109
    v_exp_f32 v110, v110
    v_cvt_pk_bf16_f32 v52, v108, v109
    s_add_u32 s29, s87, 1058816
    buffer_load_dwordx4 v[152:155], v14, s[44:47], s29 offen sc1
    v_exp_f32 v111, v111
    v_exp_f32 v112, v112
    v_cvt_pk_bf16_f32 v53, v110, v111
    v_exp_f32 v113, v113
    v_mfma_f32_32x32x16_bf16 v[76:91], v[40:43], v[56:59], v[76:91]
    s_not_b64 exec, s[70:71]
    ds_read_b128 v[36:39], v7 offset:37440
    ds_read_b128 v[40:43], v8 offset:37440
    s_mov_b64 exec, -1
    v_exp_f32 v114, v114
    v_cvt_pk_bf16_f32 v54, v112, v113
    v_exp_f32 v115, v115
    v_exp_f32 v116, v116
    v_cvt_pk_bf16_f32 v55, v114, v115
    v_exp_f32 v117, v117
    v_exp_f32 v118, v118
    v_exp_f32 v119, v119
    v_mfma_f32_32x32x16_bf16 v[76:91], v[44:47], v[52:55], v[76:91]
    v_cvt_pk_bf16_f32 v56, v116, v117
    v_exp_f32 v120, v120
    v_cvt_pk_bf16_f32 v57, v118, v119
    v_exp_f32 v121, v121
    v_exp_f32 v122, v122
    v_cvt_pk_bf16_f32 v58, v120, v121
    v_exp_f32 v123, v123
    v_exp_f32 v92, v92
    v_cvt_pk_bf16_f32 v59, v122, v123
    s_waitcnt lgkmcnt(0)
    v_mfma_f32_32x32x16_bf16 v[108:123], v[32:35], v[24:27], 0
    ds_read_b128 v[28:31], v4 offset:38912
    v_exp_f32 v93, v93
    v_exp_f32 v94, v94
    v_cvt_pk_bf16_f32 v52, v92, v93
    s_add_u32 s29, s87, 1062912
    buffer_load_dwordx4 v[156:159], v14, s[44:47], s29 offen sc1
    v_exp_f32 v95, v95
    v_exp_f32 v96, v96
    v_cvt_pk_bf16_f32 v53, v94, v95
    v_exp_f32 v97, v97
    v_mfma_f32_32x32x16_bf16 v[76:91], v[48:51], v[56:59], v[76:91]
    s_not_b64 exec, s[70:71]
    ds_read_b128 v[44:47], v7 offset:38480
    ds_read_b128 v[48:51], v8 offset:38480
    s_mov_b64 exec, -1
    v_exp_f32 v98, v98
    v_cvt_pk_bf16_f32 v54, v96, v97
    v_exp_f32 v99, v99
    v_exp_f32 v100, v100
    v_cvt_pk_bf16_f32 v55, v98, v99
    v_exp_f32 v101, v101
    v_exp_f32 v102, v102
    v_exp_f32 v103, v103
    v_mfma_f32_32x32x16_bf16 v[76:91], v[36:39], v[52:55], v[76:91]
    v_cvt_pk_bf16_f32 v56, v100, v101
    v_exp_f32 v104, v104
    v_cvt_pk_bf16_f32 v57, v102, v103
    v_exp_f32 v105, v105
    v_exp_f32 v106, v106
    v_cvt_pk_bf16_f32 v58, v104, v105
    v_exp_f32 v107, v107
    buffer_load_dword v9, v5, s[44:47], s91 offen sc1
    buffer_load_dword v125, v5, s[44:47], s77 offen sc1
    v_add_u32 v17, s94, v4
    v_lshrrev_b32 v17, 10, v17
    v_lshl_add_u32 v17, v17, 7, v4
    v_exp_f32 v108, v108
    v_cvt_pk_bf16_f32 v59, v106, v107
    s_waitcnt lgkmcnt(0)
    v_mfma_f32_32x32x16_bf16 v[92:107], v[28:31], v[24:27], 0
    ds_read_b128 v[32:35], v4 offset:39936
    v_exp_f32 v109, v109
    v_exp_f32 v110, v110
    v_cvt_pk_bf16_f32 v52, v108, v109
    s_add_u32 s29, s87, 1064960
    buffer_load_dwordx4 v[160:163], v14, s[44:47], s29 offen sc1
    v_exp_f32 v111, v111
    v_exp_f32 v112, v112
    v_cvt_pk_bf16_f32 v53, v110, v111
    v_exp_f32 v113, v113
    v_mfma_f32_32x32x16_bf16 v[76:91], v[40:43], v[56:59], v[76:91]
    s_not_b64 exec, s[70:71]
    ds_read_b128 v[36:39], v7 offset:39520
    ds_read_b128 v[40:43], v8 offset:39520
    s_mov_b64 exec, -1
    v_exp_f32 v114, v114
    v_cvt_pk_bf16_f32 v54, v112, v113
    v_exp_f32 v115, v115
    v_exp_f32 v116, v116
    v_cvt_pk_bf16_f32 v55, v114, v115
    v_exp_f32 v117, v117
    v_exp_f32 v118, v118
    v_exp_f32 v119, v119
    v_mfma_f32_32x32x16_bf16 v[76:91], v[44:47], v[52:55], v[76:91]
    v_cvt_pk_bf16_f32 v56, v116, v117
    v_exp_f32 v120, v120
    v_cvt_pk_bf16_f32 v57, v118, v119
    v_exp_f32 v121, v121
    v_exp_f32 v122, v122
    v_cvt_pk_bf16_f32 v58, v120, v121
    v_exp_f32 v123, v123
    s_cmp_lt_u32 s28, 4
    s_cbranch_scc0 L_pr30
    s_setprio 1
L_pr30:
    v_exp_f32 v92, v92
    v_cvt_pk_bf16_f32 v59, v122, v123
    s_waitcnt lgkmcnt(0)
    v_mfma_f32_32x32x16_bf16 v[108:123], v[32:35], v[24:27], 0
    ds_read_b128 v[28:31], v4 offset:40960
    v_exp_f32 v93, v93
    v_exp_f32 v94, v94
    v_cvt_pk_bf16_f32 v52, v92, v93
    s_add_u32 s29, s87, 1069056
    buffer_load_dwordx4 v[164:167], v14, s[44:47], s29 offen sc1
    v_exp_f32 v95, v95
    v_exp_f32 v96, v96
    v_cvt_pk_bf16_f32 v53, v94, v95
    v_exp_f32 v97, v97
    v_mfma_f32_32x32x16_bf16 v[76:91], v[48:51], v[56:59], v[76:91]
    s_not_b64 exec, s[70:71]
    ds_read_b128 v[44:47], v7 offset:40560
    ds_read_b128 v[48:51], v8 offset:40560
    s_mov_b64 exec, -1
    v_exp_f32 v98, v98
    v_cvt_pk_bf16_f32 v54, v96, v97
    v_exp_f32 v99, v99
    v_exp_f32 v100, v100
    v_cvt_pk_bf16_f32 v55, v98, v99
    v_exp_f32 v101, v101
    v_exp_f32 v102, v102
    v_exp_f32 v103, v103
    v_mfma_f32_32x32x16_bf16 v[76:91], v[36:39], v[52:55], v[76:91]
    v_cvt_pk_bf16_f32 v56, v100, v101
    v_exp_f32 v104, v104
    v_cvt_pk_bf16_f32 v57, v102, v103
    v_exp_f32 v105, v105
    v_exp_f32 v106, v106
    v_cvt_pk_bf16_f32 v58, v104, v105
    v_exp_f32 v107, v107
    v_exp_f32 v108, v108
    v_cvt_pk_bf16_f32 v59, v106, v107
    s_waitcnt lgkmcnt(0)
    v_mfma_f32_32x32x16_bf16 v[92:107], v[28:31], v[24:27], 0
    ds_read_b128 v[32:35], v4 offset:41984
    v_exp_f32 v109, v109
    v_exp_f32 v110, v110
    v_cvt_pk_bf16_f32 v52, v108, v109
    s_add_u32 s29, s87, 1073152
    buffer_load_dwordx4 v[168:171], v14, s[44:47], s29 offen sc1
    v_exp_f32 v111, v111
    v_exp_f32 v112, v112
    v_cvt_pk_bf16_f32 v53, v110, v111
    v_exp_f32 v113, v113
    v_mfma_f32_32x32x16_bf16 v[76:91], v[40:43], v[56:59], v[76:91]
    s_not_b64 exec, s[70:71]
    ds_read_b128 v[36:39], v7 offset:41600
    ds_read_b128 v[40:43], v8 offset:41600
    s_mov_b64 exec, -1
    v_exp_f32 v114, v114
    v_cvt_pk_bf16_f32 v54, v112, v113
    v_exp_f32 v115, v115
    v_exp_f32 v116, v116
    v_cvt_pk_bf16_f32 v55, v114, v115
    v_exp_f32 v117, v117
    v_exp_f32 v118, v118
    v_exp_f32 v119, v119
    v_mfma_f32_32x32x16_bf16 v[76:91], v[44:47], v[52:55], v[76:91]
    v_cvt_pk_bf16_f32 v56, v116, v117
    v_exp_f32 v120, v120
    v_cvt_pk_bf16_f32 v57, v118, v119
    v_exp_f32 v121, v121
    v_exp_f32 v122, v122
    v_cvt_pk_bf16_f32 v58, v120, v121
    v_exp_f32 v123, v123
    s_mov_b32 s68, -1
    s_waitcnt vmcnt(4)
    s_mov_b32 s65, 400000
L_chk31:
    v_cmp_ne_u32 vcc, 0, v9
    s_and_b64 s[66:67], vcc, s[68:69]
    s_cmp_eq_u64 s[66:67], s[68:69]
    s_cbranch_scc1 L_chk31_ok
    s_sub_u32 s65, s65, 1
    s_cbranch_scc1 L_chk31_ok
    buffer_load_dword v9, v5, s[44:47], s91 offen sc1
    s_waitcnt vmcnt(0)
    s_branch L_chk31
L_chk31_ok:
    s_waitcnt vmcnt(3)
    s_mov_b32 s65, 400000
L_chk32:
    v_cmp_ne_u32 vcc, 0, v125
    s_and_b64 s[66:67], vcc, s[68:69]
    s_cmp_eq_u64 s[66:67], s[68:69]
    s_cbranch_scc1 L_chk32_ok
    s_sub_u32 s65, s65, 1
    s_cbranch_scc1 L_chk32_ok
    buffer_load_dword v125, v5, s[44:47], s77 offen sc1
    s_waitcnt vmcnt(0)
    s_branch L_chk32
L_chk32_ok:
    s_lshr_b32 s3, s26, 1
    s_lshl_b32 s3, s3, 9
    s_and_b32 s10, s26, 1
    s_lshl_b32 s10, s10, 5
    s_add_u32 s3, s3, s10
    s_add_u32 s3, s3, 17891328
    v_bfe_u32 v3, v1, 2, 3
    v_and_b32 v2, 3, v1
    v_lshlrev_b32 v3, 6, v3
    v_lshl_add_u32 v3, v2, 3, v3
    buffer_load_dwordx2 v[20:21], v3, s[44:47], s3 offen sc1
    s_cmp_lt_u32 s28, 4
    s_cbranch_scc1 L_pr33
    s_setprio 1
L_pr33:
    v_exp_f32 v92, v92
    v_cvt_pk_bf16_f32 v59, v122, v123
    s_waitcnt lgkmcnt(0)
    v_mfma_f32_32x32x16_bf16 v[108:123], v[32:35], v[24:27], 0
    ds_read_b128 v[28:31], v4 offset:43008
    v_exp_f32 v93, v93
    v_exp_f32 v94, v94
    v_cvt_pk_bf16_f32 v52, v92, v93
    s_add_u32 m0, s92, 0
    s_add_u32 s3, s86, 0
    buffer_load_dwordx4 v17, s[44:47], s3 offen sc1 lds
    v_exp_f32 v95, v95
    v_exp_f32 v96, v96
    v_cvt_pk_bf16_f32 v53, v94, v95
    v_exp_f32 v97, v97
    v_mfma_f32_32x32x16_bf16 v[76:91], v[48:51], v[56:59], v[76:91]
    s_not_b64 exec, s[70:71]
    ds_read_b128 v[44:47], v7 offset:42640
    ds_read_b128 v[48:51], v8 offset:42640
    s_mov_b64 exec, -1
    v_exp_f32 v98, v98
    v_cvt_pk_bf16_f32 v54, v96, v97
    v_exp_f32 v99, v99
    v_exp_f32 v100, v100
    v_cvt_pk_bf16_f32 v55, v98, v99
    v_exp_f32 v101, v101
    v_exp_f32 v102, v102
    v_exp_f32 v103, v103
    v_mfma_f32_32x32x16_bf16 v[76:91], v[36:39], v[52:55], v[76:91]
    s_add_u32 s29, s87, 1067008
    buffer_load_dwordx4 v[176:179], v14, s[44:47], s29 offen sc1
    v_cvt_pk_bf16_f32 v56, v100, v101
    v_exp_f32 v104, v104
    v_cvt_pk_bf16_f32 v57, v102, v103
    v_exp_f32 v105, v105
    v_exp_f32 v106, v106
    v_cvt_pk_bf16_f32 v58, v104, v105
    v_exp_f32 v107, v107
    v_exp_f32 v108, v108
    v_cvt_pk_bf16_f32 v59, v106, v107
    s_waitcnt lgkmcnt(0)
    v_mfma_f32_32x32x16_bf16 v[92:107], v[28:31], v[24:27], 0
    ds_read_b128 v[32:35], v4 offset:44032
    v_exp_f32 v109, v109
    v_exp_f32 v110, v110
    v_cvt_pk_bf16_f32 v52, v108, v109
    s_add_u32 m0, s92, 1024
    s_add_u32 s3, s86, 2048
    buffer_load_dwordx4 v17, s[44:47], s3 offen sc1 lds
    v_exp_f32 v111, v111
    v_exp_f32 v112, v112
    v_cvt_pk_bf16_f32 v53, v110, v111
    v_exp_f32 v113, v113
    v_mfma_f32_32x32x16_bf16 v[76:91], v[40:43], v[56:59], v[76:91]
    s_not_b64 exec, s[70:71]
    ds_read_b128 v[36:39], v7 offset:43680
    ds_read_b128 v[40:43], v8 offset:43680
    s_mov_b64 exec, -1
    v_exp_f32 v114, v114
    v_cvt_pk_bf16_f32 v54, v112, v113
    v_exp_f32 v115, v115
    v_exp_f32 v116, v116
    v_cvt_pk_bf16_f32 v55, v114, v115
    v_exp_f32 v117, v117
    v_exp_f32 v118, v118
    v_exp_f32 v119, v119
    v_mfma_f32_32x32x16_bf16 v[76:91], v[44:47], v[52:55], v[76:91]
    s_add_u32 s29, s87, 1071104
    buffer_load_dwordx4 v[180:183], v14, s[44:47], s29 offen sc1
    v_cvt_pk_bf16_f32 v56, v116, v117
    v_exp_f32 v120, v120
    v_cvt_pk_bf16_f32 v57, v118, v119
    v_exp_f32 v121, v121
    v_exp_f32 v122, v122
    v_cvt_pk_bf16_f32 v58, v120, v121
    v_exp_f32 v123, v123
    v_exp_f32 v92, v92
    v_cvt_pk_bf16_f32 v59, v122, v123
    s_waitcnt lgkmcnt(0)
    v_mfma_f32_32x32x16_bf16 v[108:123], v[32:35], v[24:27], 0
    ds_read_b128 v[28:31], v4 offset:45056
    v_exp_f32 v93, v93
    v_exp_f32 v94, v94
    v_cvt_pk_bf16_f32 v52, v92, v93
    s_add_u32 m0, s92, 2048
    s_add_u32 s3, s86, 4096
    buffer_load_dwordx4 v17, s[44:47], s3 offen sc1 lds
    v_exp_f32 v95, v95
    v_exp_f32 v96, v96
    v_cvt_pk_bf16_f32 v53, v94, v95
    v_exp_f32 v97, v97
    v_mfma_f32_32x32x16_bf16 v[76:91], v[48:51], v[56:59], v[76:91]
    s_not_b64 exec, s[70:71]
    ds_read_b128 v[44:47], v7 offset:44720
    ds_read_b128 v[48:51], v8 offset:44720
    s_mov_b64 exec, -1
    v_exp_f32 v98, v98
    v_cvt_pk_bf16_f32 v54, v96, v97
    v_exp_f32 v99, v99
    v_exp_f32 v100, v100
    v_cvt_pk_bf16_f32 v55, v98, v99
    v_exp_f32 v101, v101
    v_exp_f32 v102, v102
    v_exp_f32 v103, v103
    v_mfma_f32_32x32x16_bf16 v[76:91], v[36:39], v[52:55], v[76:91]
    s_add_u32 s29, s87, 1075200
    buffer_load_dwordx4 v[184:187], v14, s[44:47], s29 offen sc1
    v_cvt_pk_bf16_f32 v56, v100, v101
    v_exp_f32 v104, v104
    v_cvt_pk_bf16_f32 v57, v102, v103
    v_exp_f32 v105, v105
    v_exp_f32 v106, v106
    v_cvt_pk_bf16_f32 v58, v104, v105
    v_exp_f32 v107, v107
    s_cmp_lt_u32 s28, 4
    s_cbranch_scc0 L_pr34
    s_setprio 0
L_pr34:
    v_exp_f32 v108, v108
    v_cvt_pk_bf16_f32 v59, v106, v107
    s_waitcnt lgkmcnt(0)
    v_mfma_f32_32x32x16_bf16 v[92:107], v[28:31], v[24:27], 0
    ds_read_b128 v[32:35], v4 offset:46080
    v_exp_f32 v109, v109
    v_exp_f32 v110, v110
    v_cvt_pk_bf16_f32 v52, v108, v109
    s_add_u32 m0, s92, 3072
    s_add_u32 s3, s86, 6144
    buffer_load_dwordx4 v17, s[44:47], s3 offen sc1 lds
    v_exp_f32 v111, v111
    v_exp_f32 v112, v112
    v_cvt_pk_bf16_f32 v53, v110, v111
    v_exp_f32 v113, v113
    v_mfma_f32_32x32x16_bf16 v[76:91], v[40:43], v[56:59], v[76:91]
    s_not_b64 exec, s[70:71]
    ds_read_b128 v[36:39], v7 offset:45760
    ds_read_b128 v[40:43], v8 offset:45760
    s_mov_b64 exec, -1
    v_exp_f32 v114, v114
    v_cvt_pk_bf16_f32 v54, v112, v113
    v_exp_f32 v115, v115
    v_exp_f32 v116, v116
    v_cvt_pk_bf16_f32 v55, v114, v115
    v_exp_f32 v117, v117
    v_exp_f32 v118, v118
    v_exp_f32 v119, v119
    v_mfma_f32_32x32x16_bf16 v[76:91], v[44:47], v[52:55], v[76:91]
    s_add_u32 s29, s87, 1079296
    buffer_load_dwordx4 v[188:191], v14, s[44:47], s29 offen sc1
    v_cvt_pk_bf16_f32 v56, v116, v117
    v_exp_f32 v120, v120
    v_cvt_pk_bf16_f32 v57, v118, v119
    v_exp_f32 v121, v121
    v_exp_f32 v122, v122
    v_cvt_pk_bf16_f32 v58, v120, v121
    v_exp_f32 v123, v123
    v_exp_f32 v92, v92
    v_cvt_pk_bf16_f32 v59, v122, v123
    s_waitcnt lgkmcnt(0)
    v_mfma_f32_32x32x16_bf16 v[108:123], v[32:35], v[24:27], 0
    ds_read_b128 v[28:31], v4 offset:47104
    v_exp_f32 v93, v93
    v_exp_f32 v94, v94
    v_cvt_pk_bf16_f32 v52, v92, v93
    s_add_u32 s29, s87, 1077248
    buffer_load_dwordx4 v[172:175], v14, s[44:47], s29 offen sc1
    v_exp_f32 v95, v95
    v_exp_f32 v96, v96
    v_cvt_pk_bf16_f32 v53, v94, v95
    v_exp_f32 v97, v97
    v_mfma_f32_32x32x16_bf16 v[76:91], v[48:51], v[56:59], v[76:91]
    s_not_b64 exec, s[70:71]
    ds_read_b128 v[44:47], v7 offset:46800
    ds_read_b128 v[48:51], v8 offset:46800
    s_mov_b64 exec, -1
    v_exp_f32 v98, v98
    v_cvt_pk_bf16_f32 v54, v96, v97
    v_exp_f32 v99, v99
    v_exp_f32 v100, v100
    v_cvt_pk_bf16_f32 v55, v98, v99
    v_exp_f32 v101, v101
    v_exp_f32 v102, v102
    v_exp_f32 v103, v103
    v_mfma_f32_32x32x16_bf16 v[76:91], v[36:39], v[52:55], v[76:91]
    v_cvt_pk_bf16_f32 v56, v100, v101
    v_exp_f32 v104, v104
    v_cvt_pk_bf16_f32 v57, v102, v103
    v_exp_f32 v105, v105
    v_exp_f32 v106, v106
    v_cvt_pk_bf16_f32 v58, v104, v105
    v_exp_f32 v107, v107
    s_cmp_lt_u32 s28, 4
    s_cbranch_scc1 L_pr35
    s_setprio 0
L_pr35:
    v_exp_f32 v108, v108
    v_cvt_pk_bf16_f32 v59, v106, v107
    s_waitcnt lgkmcnt(0)
    v_mfma_f32_32x32x16_bf16 v[92:107], v[28:31], v[24:27], 0
    ds_read_b128 v[32:35], v4 offset:48128
    v_exp_f32 v109, v109
    v_exp_f32 v110, v110
    v_cvt_pk_bf16_f32 v52, v108, v109
    s_add_u32 s29, s87, 0
    buffer_load_dwordx4 v[208:211], v14, s[44:47], s29 offen sc1
    v_exp_f32 v111, v111
    v_exp_f32 v112, v112
    v_cvt_pk_bf16_f32 v53, v110, v111
    v_exp_f32 v113, v113
    v_mfma_f32_32x32x16_bf16 v[76:91], v[40:43], v[56:59], v[76:91]
    s_not_b64 exec, s[70:71]
    ds_read_b128 v[36:39], v7 offset:47840
    ds_read_b128 v[40:43], v8 offset:47840
    s_mov_b64 exec, -1
    v_exp_f32 v114, v114
    v_cvt_pk_bf16_f32 v54, v112, v113
    v_exp_f32 v115, v115
    v_exp_f32 v116, v116
    v_cvt_pk_bf16_f32 v55, v114, v115
    v_exp_f32 v117, v117
    v_exp_f32 v118, v118
    v_exp_f32 v119, v119
    v_mfma_f32_32x32x16_bf16 v[76:91], v[44:47], v[52:55], v[76:91]
    v_cvt_pk_bf16_f32 v56, v116, v117
    v_exp_f32 v120, v120
    v_cvt_pk_bf16_f32 v57, v118, v119
    v_exp_f32 v121, v121
    v_exp_f32 v122, v122
    v_cvt_pk_bf16_f32 v58, v120, v121
    v_exp_f32 v123, v123
    v_exp_f32 v92, v92
    v_cvt_pk_bf16_f32 v59, v122, v123
    s_waitcnt lgkmcnt(0)
    v_mfma_f32_32x32x16_bf16 v[108:123], v[32:35], v[24:27], 0
    ds_read_b128 v[28:31], v4 offset:49152
    v_exp_f32 v93, v93
    v_exp_f32 v94, v94
    v_cvt_pk_bf16_f32 v52, v92, v93
    s_add_u32 s29, s87, 2048
    buffer_load_dwordx4 v[212:215], v14, s[44:47], s29 offen sc1
    v_exp_f32 v95, v95
    v_exp_f32 v96, v96
    v_cvt_pk_bf16_f32 v53, v94, v95
    v_exp_f32 v97, v97
    v_mfma_f32_32x32x16_bf16 v[76:91], v[48:51], v[56:59], v[76:91]
    s_not_b64 exec, s[70:71]
    ds_read_b128 v[44:47], v7 offset:48880
    ds_read_b128 v[48:51], v8 offset:48880
    s_mov_b64 exec, -1
    v_exp_f32 v98, v98
    v_cvt_pk_bf16_f32 v54, v96, v97
    v_exp_f32 v99, v99
    v_exp_f32 v100, v100
    v_cvt_pk_bf16_f32 v55, v98, v99
    v_exp_f32 v101, v101
    v_exp_f32 v102, v102
    v_exp_f32 v103, v103
    v_mfma_f32_32x32x16_bf16 v[76:91], v[36:39], v[52:55], v[76:91]
    v_cvt_pk_bf16_f32 v56, v100, v101
    v_exp_f32 v104, v104
    v_cvt_pk_bf16_f32 v57, v102, v103
    v_exp_f32 v105, v105
    v_exp_f32 v106, v106
    v_cvt_pk_bf16_f32 v58, v104, v105
    v_exp_f32 v107, v107
    s_waitcnt vmcnt(4)
    s_barrier
    s_setprio 3
    v_exp_f32 v108, v108
    v_cvt_pk_bf16_f32 v59, v106, v107
    s_waitcnt lgkmcnt(0)
    v_mfma_f32_32x32x16_bf16 v[92:107], v[28:31], v[24:27], 0
    ds_read_b128 v[32:35], v4 offset:50176
    v_exp_f32 v109, v109
    v_exp_f32 v110, v110
    v_cvt_pk_bf16_f32 v52, v108, v109
    s_add_u32 s29, s87, 4096
    buffer_load_dwordx4 v[216:219], v14, s[44:47], s29 offen sc1
    v_exp_f32 v111, v111
    v_exp_f32 v112, v112
    v_cvt_pk_bf16_f32 v53, v110, v111
    v_exp_f32 v113, v113
    v_mfma_f32_32x32x16_bf16 v[76:91], v[40:43], v[56:59], v[76:91]
    s_not_b64 exec, s[70:71]
    ds_read_b128 v[36:39], v7 offset:49920
    ds_read_b128 v[40:43], v8 offset:49920
    s_mov_b64 exec, -1
    v_exp_f32 v114, v114
    v_cvt_pk_bf16_f32 v54, v112, v113
    v_exp_f32 v115, v115
    v_exp_f32 v116, v116
    ds_read_b128 v[10:13], v6 offset:12288
    v_cvt_pk_bf16_f32 v55, v114, v115
    v_exp_f32 v117, v117
    v_exp_f32 v118, v118
    v_exp_f32 v119, v119
    v_mfma_f32_32x32x16_bf16 v[76:91], v[44:47], v[52:55], v[76:91]
    v_cvt_pk_bf16_f32 v56, v116, v117
    v_exp_f32 v120, v120
    v_cvt_pk_bf16_f32 v57, v118, v119
    v_exp_f32 v121, v121
    v_exp_f32 v122, v122
    v_cvt_pk_bf16_f32 v58, v120, v121
    v_exp_f32 v123, v123
    v_exp_f32 v92, v92
    v_cvt_pk_bf16_f32 v59, v122, v123
    s_waitcnt lgkmcnt(0)
    v_mfma_f32_32x32x16_bf16 v[108:123], v[32:35], v[24:27], 0
    ds_read_b128 v[28:31], v4 offset:51200
    v_exp_f32 v93, v93
    v_exp_f32 v94, v94
    v_cvt_pk_bf16_f32 v52, v92, v93
    s_add_u32 s29, s87, 6144
    buffer_load_dwordx4 v[220:223], v14, s[44:47], s29 offen sc1
    v_exp_f32 v95, v95
    v_exp_f32 v96, v96
    v_cvt_pk_bf16_f32 v53, v94, v95
    v_exp_f32 v97, v97
    v_mfma_f32_32x32x16_bf16 v[76:91], v[48:51], v[56:59], v[76:91]
    s_not_b64 exec, s[70:71]
    ds_read_b128 v[44:47], v7 offset:50960
    ds_read_b128 v[48:51], v8 offset:50960
    s_mov_b64 exec, -1
    v_exp_f32 v98, v98
    v_cvt_pk_bf16_f32 v54, v96, v97
    v_exp_f32 v99, v99
    v_exp_f32 v100, v100
    v_mfma_f32_32x32x16_bf16 v[192:207], v[128:131], v[10:13], 0
    ds_read_b128 v[10:13], v6 offset:13312
    v_cvt_pk_bf16_f32 v55, v98, v99
    v_exp_f32 v101, v101
    v_exp_f32 v102, v102
    v_exp_f32 v103, v103
    v_mfma_f32_32x32x16_bf16 v[76:91], v[36:39], v[52:55], v[76:91]
    v_cvt_pk_bf16_f32 v56, v100, v101
    v_exp_f32 v104, v104
    v_cvt_pk_bf16_f32 v57, v102, v103
    v_exp_f32 v105, v105
    v_exp_f32 v106, v106
    v_cvt_pk_bf16_f32 v58, v104, v105
    v_exp_f32 v107, v107
    s_cmp_lt_u32 s28, 4
    s_cbranch_scc0 L_pr36
    s_setprio 2
L_pr36:
    v_exp_f32 v108, v108
    v_cvt_pk_bf16_f32 v59, v106, v107
    s_waitcnt lgkmcnt(0)
    v_mfma_f32_32x32x16_bf16 v[92:107], v[28:31], v[24:27], 0
    ds_read_b128 v[32:35], v4 offset:52224
    v_exp_f32 v109, v109
    v_exp_f32 v110, v110
    v_cvt_pk_bf16_f32 v52, v108, v109
    s_add_u32 s29, s87, 8192
    buffer_load_dwordx4 v[224:227], v14, s[44:47], s29 offen sc1
    v_exp_f32 v111, v111
    v_exp_f32 v112, v112
    v_cvt_pk_bf16_f32 v53, v110, v111
    v_exp_f32 v113, v113
    v_mfma_f32_32x32x16_bf16 v[76:91], v[40:43], v[56:59], v[76:91]
    s_not_b64 exec, s[70:71]
    ds_read_b128 v[36:39], v7 offset:52000
    ds_read_b128 v[40:43], v8 offset:52000
    s_mov_b64 exec, -1
    v_exp_f32 v114, v114
    v_cvt_pk_bf16_f32 v54, v112, v113
    v_exp_f32 v115, v115
    v_exp_f32 v116, v116
    v_mfma_f32_32x32x16_bf16 v[192:207], v[132:135], v[10:13], v[192:207]
    ds_read_b128 v[10:13], v6 offset:14336
    v_cvt_pk_bf16_f32 v55, v114, v115
    v_exp_f32 v117, v117
    v_exp_f32 v118, v118
    v_exp_f32 v119, v119
    v_mfma_f32_32x32x16_bf16 v[76:91], v[44:47], v[52:55], v[76:91]
    v_cvt_pk_bf16_f32 v56, v116, v117
    v_exp_f32 v120, v120
    v_cvt_pk_bf16_f32 v57, v118, v119
    v_exp_f32 v121, v121
    v_exp_f32 v122, v122
    v_cvt_pk_bf16_f32 v58, v120, v121
    v_exp_f32 v123, v123
    v_exp_f32 v92, v92
    v_cvt_pk_bf16_f32 v59, v122, v123
    s_waitcnt lgkmcnt(0)
    v_mfma_f32_32x32x16_bf16 v[108:123], v[32:35], v[24:27], 0
    ds_read_b128 v[28:31], v4 offset:53248
    v_exp_f32 v93, v93
    v_exp_f32 v94, v94
    v_cvt_pk_bf16_f32 v52, v92, v93
    s_add_u32 s29, s87, 10240
    buffer_load_dwordx4 v[228:231], v14, s[44:47], s29 offen sc1
    v_exp_f32 v95, v95
    v_exp_f32 v96, v96
    v_cvt_pk_bf16_f32 v53, v94, v95
    v_exp_f32 v97, v97
    v_mfma_f32_32x32x16_bf16 v[76:91], v[48:51], v[56:59], v[76:91]
    s_not_b64 exec, s[70:71]
    ds_read_b128 v[44:47], v7 offset:53040
    ds_read_b128 v[48:51], v8 offset:53040
    s_mov_b64 exec, -1
    v_exp_f32 v98, v98
    v_cvt_pk_bf16_f32 v54, v96, v97
    v_exp_f32 v99, v99
    v_exp_f32 v100, v100
    v_mfma_f32_32x32x16_bf16 v[192:207], v[136:139], v[10:13], v[192:207]
    ds_read_b128 v[10:13], v6 offset:15360
    v_cvt_pk_bf16_f32 v55, v98, v99
    v_exp_f32 v101, v101
    v_exp_f32 v102, v102
    v_exp_f32 v103, v103
    v_mfma_f32_32x32x16_bf16 v[76:91], v[36:39], v[52:55], v[76:91]
    v_cvt_pk_bf16_f32 v56, v100, v101
    v_exp_f32 v104, v104
    v_cvt_pk_bf16_f32 v57, v102, v103
    v_exp_f32 v105, v105
    v_exp_f32 v106, v106
    v_cvt_pk_bf16_f32 v58, v104, v105
    v_exp_f32 v107, v107
    s_cmp_lt_u32 s28, 4
    s_cbranch_scc1 L_pr37
    s_setprio 2
L_pr37:
    v_exp_f32 v108, v108
    v_cvt_pk_bf16_f32 v59, v106, v107
    s_waitcnt lgkmcnt(0)
    v_mfma_f32_32x32x16_bf16 v[92:107], v[28:31], v[24:27], 0
    ds_read_b128 v[32:35], v4 offset:54272
    v_exp_f32 v109, v109
    v_exp_f32 v110, v110
    v_cvt_pk_bf16_f32 v52, v108, v109
    s_add_u32 s29, s87, 12288
    buffer_load_dwordx4 v[232:235], v14, s[44:47], s29 offen sc1
    v_exp_f32 v111, v111
    v_exp_f32 v112, v112
    v_cvt_pk_bf16_f32 v53, v110, v111
    v_exp_f32 v113, v113
    v_mfma_f32_32x32x16_bf16 v[76:91], v[40:43], v[56:59], v[76:91]
    s_not_b64 exec, s[70:71]
    ds_read_b128 v[36:39], v7 offset:54080
    ds_read_b128 v[40:43], v8 offset:54080
    s_mov_b64 exec, -1
    v_exp_f32 v114, v114
    v_cvt_pk_bf16_f32 v54, v112, v113
    v_exp_f32 v115, v115
    v_exp_f32 v116, v116
    v_mfma_f32_32x32x16_bf16 v[192:207], v[140:143], v[10:13], v[192:207]
    v_cvt_pk_bf16_f32 v55, v114, v115
    v_exp_f32 v117, v117
    v_exp_f32 v118, v118
    v_exp_f32 v119, v119
    v_mfma_f32_32x32x16_bf16 v[76:91], v[44:47], v[52:55], v[76:91]
    v_cvt_pk_bf16_f32 v56, v116, v117
    v_exp_f32 v120, v120
    v_cvt_pk_bf16_f32 v57, v118, v119
    v_exp_f32 v121, v121
    v_exp_f32 v122, v122
    v_cvt_pk_bf16_f32 v58, v120, v121
    v_exp_f32 v123, v123
    s_cmp_lt_u32 s28, 4
    s_cbranch_scc0 L_pr38
    s_setprio 1
L_pr38:
    v_exp_f32 v92, v92
    v_cvt_pk_bf16_f32 v59, v122, v123
    s_waitcnt lgkmcnt(0)
    v_mfma_f32_32x32x16_bf16 v[108:123], v[32:35], v[24:27], 0
    ds_read_b128 v[28:31], v4 offset:55296
    v_exp_f32 v93, v93
    v_exp_f32 v94, v94
    v_cvt_pk_bf16_f32 v52, v92, v93
    s_add_u32 s29, s87, 14336
    buffer_load_dwordx4 v[236:239], v14, s[44:47], s29 offen sc1
    v_exp_f32 v95, v95
    v_exp_f32 v96, v96
    v_cvt_pk_bf16_f32 v53, v94, v95
    v_exp_f32 v97, v97
    v_mfma_f32_32x32x16_bf16 v[76:91], v[48:51], v[56:59], v[76:91]
    s_not_b64 exec, s[70:71]
    ds_read_b128 v[44:47], v7 offset:55120
    ds_read_b128 v[48:51], v8 offset:55120
    s_mov_b64 exec, -1
    v_exp_f32 v98, v98
    v_cvt_pk_bf16_f32 v54, v96, v97
    v_exp_f32 v99, v99
    v_exp_f32 v100, v100
    v_cvt_pk_bf16_f32 v55, v98, v99
    v_exp_f32 v101, v101
    v_exp_f32 v102, v102
    v_exp_f32 v103, v103
    v_mfma_f32_32x32x16_bf16 v[76:91], v[36:39], v[52:55], v[76:91]
    v_cvt_pk_bf16_f32 v56, v100, v101
    v_exp_f32 v104, v104
    v_cvt_pk_bf16_f32 v57, v102, v103
    v_exp_f32 v105, v105
    v_exp_f32 v106, v106
    v_cvt_pk_bf16_f32 v58, v104, v105
    v_exp_f32 v107, v107
    v_exp_f32 v108, v108
    v_cvt_pk_bf16_f32 v59, v106, v107
    s_waitcnt lgkmcnt(0)
    v_mfma_f32_32x32x16_bf16 v[92:107], v[28:31], v[24:27], 0
    ds_read_b128 v[32:35], v4 offset:56320
    v_exp_f32 v109, v109
    v_exp_f32 v110, v110
    v_cvt_pk_bf16_f32 v52, v108, v109
    s_add_u32 s29, s87, 16384
    buffer_load_dwordx4 v[240:243], v14, s[44:47], s29 offen sc1
    v_exp_f32 v111, v111
    v_exp_f32 v112, v112
    v_cvt_pk_bf16_f32 v53, v110, v111
    v_exp_f32 v113, v113
    v_mfma_f32_32x32x16_bf16 v[76:91], v[40:43], v[56:59], v[76:91]
    s_not_b64 exec, s[70:71]
    ds_read_b128 v[36:39], v7 offset:56160
    ds_read_b128 v[40:43], v8 offset:56160
    s_mov_b64 exec, -1
    v_exp_f32 v114, v114
    v_cvt_pk_bf16_f32 v54, v112, v113
    v_exp_f32 v115, v115
    v_exp_f32 v116, v116
    v_cvt_pk_bf16_f32 v55, v114, v115
    v_exp_f32 v117, v117
    v_exp_f32 v118, v118
    v_exp_f32 v119, v119
    v_mfma_f32_32x32x16_bf16 v[76:91], v[44:47], v[52:55], v[76:91]
    v_cvt_pk_bf16_f32 v56, v116, v117
    v_exp_f32 v120, v120
    v_cvt_pk_bf16_f32 v57, v118, v119
    v_exp_f32 v121, v121
    v_exp_f32 v122, v122
    v_cvt_pk_bf16_f32 v58, v120, v121
    v_exp_f32 v123, v123
    s_cmp_lt_u32 s28, 4
    s_cbranch_scc1 L_pr39
    s_setprio 1
L_pr39:
    v_exp_f32 v92, v92
    v_cvt_pk_bf16_f32 v59, v122, v123
    s_waitcnt lgkmcnt(0)
    v_mfma_f32_32x32x16_bf16 v[108:123], v[32:35], v[24:27], 0
    ds_read_b128 v[28:31], v4 offset:57344
    v_exp_f32 v93, v93
    v_exp_f32 v94, v94
    v_cvt_pk_bf16_f32 v52, v92, v93
    s_add_u32 s29, s87, 18432
    buffer_load_dwordx4 v[244:247], v14, s[44:47], s29 offen sc1
    v_exp_f32 v95, v95
    v_exp_f32 v96, v96
    v_cvt_pk_bf16_f32 v53, v94, v95
    v_exp_f32 v97, v97
    v_mfma_f32_32x32x16_bf16 v[76:91], v[48:51], v[56:59], v[76:91]
    s_not_b64 exec, s[70:71]
    ds_read_b128 v[44:47], v7 offset:57200
    ds_read_b128 v[48:51], v8 offset:57200
    s_mov_b64 exec, -1
    v_exp_f32 v98, v98
    v_cvt_pk_bf16_f32 v54, v96, v97
    v_exp_f32 v99, v99
    v_exp_f32 v100, v100
    v_cvt_pk_bf16_f32 v55, v98, v99
    v_exp_f32 v101, v101
    v_exp_f32 v102, v102
    v_exp_f32 v103, v103
    v_mfma_f32_32x32x16_bf16 v[76:91], v[36:39], v[52:55], v[76:91]
    v_cvt_pk_bf16_f32 v56, v100, v101
    v_exp_f32 v104, v104
    v_cvt_pk_bf16_f32 v57, v102, v103
    v_exp_f32 v105, v105
    v_exp_f32 v106, v106
    v_cvt_pk_bf16_f32 v58, v104, v105
    v_exp_f32 v107, v107
    s_cmp_lt_u32 s28, 4
    s_cbranch_scc0 L_pr40
    s_setprio 0
L_pr40:
    v_exp_f32 v108, v108
    v_cvt_pk_bf16_f32 v59, v106, v107
    s_waitcnt lgkmcnt(0)
    v_mfma_f32_32x32x16_bf16 v[92:107], v[28:31], v[24:27], 0
    ds_read_b128 v[32:35], v4 offset:58368
    v_exp_f32 v109, v109
    v_exp_f32 v110, v110
    v_cvt_pk_bf16_f32 v52, v108, v109
    s_add_u32 s29, s87, 20480
    buffer_load_dwordx4 v[248:251], v14, s[44:47], s29 offen sc1
    v_exp_f32 v111, v111
    v_exp_f32 v112, v112
    v_cvt_pk_bf16_f32 v53, v110, v111
    v_exp_f32 v113, v113
    v_mfma_f32_32x32x16_bf16 v[76:91], v[40:43], v[56:59], v[76:91]
    s_not_b64 exec, s[70:71]
    ds_read_b128 v[36:39], v7 offset:58240
    ds_read_b128 v[40:43], v8 offset:58240
    s_mov_b64 exec, -1
    v_exp_f32 v114, v114
    v_cvt_pk_bf16_f32 v54, v112, v113
    v_exp_f32 v115, v115
    v_exp_f32 v116, v116
    v_cvt_pk_bf16_f32 v55, v114, v115
    v_exp_f32 v117, v117
    v_exp_f32 v118, v118
    v_exp_f32 v119, v119
    v_mfma_f32_32x32x16_bf16 v[76:91], v[44:47], v[52:55], v[76:91]
    v_cvt_pk_bf16_f32 v56, v116, v117
    v_exp_f32 v120, v120
    v_cvt_pk_bf16_f32 v57, v118, v119
    v_exp_f32 v121, v121
    v_exp_f32 v122, v122
    v_cvt_pk_bf16_f32 v58, v120, v121
    v_exp_f32 v123, v123
    v_exp_f32 v92, v92
    v_cvt_pk_bf16_f32 v59, v122, v123
    s_waitcnt lgkmcnt(0)
    v_mfma_f32_32x32x16_bf16 v[108:123], v[32:35], v[24:27], 0
    ds_read_b128 v[28:31], v4 offset:59392
    v_exp_f32 v93, v93
    v_exp_f32 v94, v94
    v_cvt_pk_bf16_f32 v52, v92, v93
    s_add_u32 s29, s87, 22528
    buffer_load_dwordx4 v[252:255], v14, s[44:47], s29 offen sc1
    v_exp_f32 v95, v95
    v_exp_f32 v96, v96
    v_cvt_pk_bf16_f32 v53, v94, v95
    v_exp_f32 v97, v97
    v_mfma_f32_32x32x16_bf16 v[76:91], v[48:51], v[56:59], v[76:91]
    s_not_b64 exec, s[70:71]
    ds_read_b128 v[44:47], v7 offset:59280
    ds_read_b128 v[48:51], v8 offset:59280
    s_mov_b64 exec, -1
    v_exp_f32 v98, v98
    v_cvt_pk_bf16_f32 v54, v96, v97
    v_exp_f32 v99, v99
    v_exp_f32 v100, v100
    v_cvt_pk_bf16_f32 v55, v98, v99
    v_exp_f32 v101, v101
    v_exp_f32 v102, v102
    v_exp_f32 v103, v103
    v_mfma_f32_32x32x16_bf16 v[76:91], v[36:39], v[52:55], v[76:91]
    v_cvt_pk_bf16_f32 v56, v100, v101
    v_exp_f32 v104, v104
    v_cvt_pk_bf16_f32 v57, v102, v103
    v_exp_f32 v105, v105
    v_exp_f32 v106, v106
    v_cvt_pk_bf16_f32 v58, v104, v105
    v_exp_f32 v107, v107
    s_cmp_lt_u32 s28, 4
    s_cbranch_scc1 L_pr41
    s_setprio 0
L_pr41:
    v_exp_f32 v108, v108
    v_cvt_pk_bf16_f32 v59, v106, v107
    s_waitcnt lgkmcnt(0)
    v_mfma_f32_32x32x16_bf16 v[92:107], v[28:31], v[24:27], 0
    ds_read_b128 v[32:35], v4 offset:60416
    v_exp_f32 v109, v109
    v_exp_f32 v110, v110
    v_cvt_pk_bf16_f32 v52, v108, v109
    s_add_u32 s29, s87, 1048576
    buffer_load_dwordx4 v[128:131], v14, s[44:47], s29 offen sc1
    v_exp_f32 v111, v111
    v_exp_f32 v112, v112
    v_cvt_pk_bf16_f32 v53, v110, v111
    v_exp_f32 v113, v113
    v_mfma_f32_32x32x16_bf16 v[76:91], v[40:43], v[56:59], v[76:91]
    s_not_b64 exec, s[70:71]
    ds_read_b128 v[36:39], v7 offset:60320
    ds_read_b128 v[40:43], v8 offset:60320
    s_mov_b64 exec, -1
    v_exp_f32 v114, v114
    v_cvt_pk_bf16_f32 v54, v112, v113
    v_exp_f32 v115, v115
    v_exp_f32 v116, v116
    v_cvt_pk_bf16_f32 v55, v114, v115
    v_exp_f32 v117, v117
    v_exp_f32 v118, v118
    v_exp_f32 v119, v119
    v_mfma_f32_32x32x16_bf16 v[76:91], v[44:47], v[52:55], v[76:91]
    v_cvt_pk_bf16_f32 v56, v116, v117
    v_exp_f32 v120, v120
    v_cvt_pk_bf16_f32 v57, v118, v119
    v_exp_f32 v121, v121
    v_exp_f32 v122, v122
    v_cvt_pk_bf16_f32 v58, v120, v121
    v_exp_f32 v123, v123
    s_barrier
    s_setprio 3
    v_exp_f32 v92, v92
    v_cvt_pk_bf16_f32 v59, v122, v123
    s_waitcnt lgkmcnt(0)
    v_mfma_f32_32x32x16_bf16 v[108:123], v[32:35], v[24:27], 0
    ds_read_b128 v[28:31], v4 offset:61440
    v_exp_f32 v93, v93
    v_exp_f32 v94, v94
    v_cvt_pk_bf16_f32 v52, v92, v93
    s_add_u32 s29, s87, 1052672
    buffer_load_dwordx4 v[132:135], v14, s[44:47], s29 offen sc1
    v_exp_f32 v95, v95
    v_exp_f32 v96, v96
    v_cvt_pk_bf16_f32 v53, v94, v95
    v_exp_f32 v97, v97
    v_mfma_f32_32x32x16_bf16 v[76:91], v[48:51], v[56:59], v[76:91]
    s_not_b64 exec, s[70:71]
    ds_read_b128 v[44:47], v7 offset:61360
    ds_read_b128 v[48:51], v8 offset:61360
    s_mov_b64 exec, -1
    v_exp_f32 v98, v98
    v_cvt_pk_bf16_f32 v54, v96, v97
    v_exp_f32 v99, v99
    v_exp_f32 v100, v100
    v_cvt_pk_bf16_f32 v55, v98, v99
    v_exp_f32 v101, v101
    v_exp_f32 v102, v102
    v_exp_f32 v103, v103
    v_mfma_f32_32x32x16_bf16 v[76:91], v[36:39], v[52:55], v[76:91]
    v_cvt_pk_bf16_f32 v56, v100, v101
    v_exp_f32 v104, v104
    v_cvt_pk_bf16_f32 v57, v102, v103
    v_exp_f32 v105, v105
    v_exp_f32 v106, v106
    v_cvt_pk_bf16_f32 v58, v104, v105
    v_exp_f32 v107, v107
    s_cmp_lt_u32 s28, 4
    s_cbranch_scc0 L_pr42
    s_setprio 2
L_pr42:
    v_exp_f32 v108, v108
    v_cvt_pk_bf16_f32 v59, v106, v107
    s_waitcnt lgkmcnt(0)
    v_mfma_f32_32x32x16_bf16 v[92:107], v[28:31], v[24:27], 0
    ds_read_b128 v[32:35], v4 offset:62464
    v_exp_f32 v109, v109
    v_exp_f32 v110, v110
    v_cvt_pk_bf16_f32 v52, v108, v109
    s_add_u32 s29, s87, 1056768
    buffer_load_dwordx4 v[136:139], v14, s[44:47], s29 offen sc1
    v_exp_f32 v111, v111
    v_exp_f32 v112, v112
    v_cvt_pk_bf16_f32 v53, v110, v111
    v_exp_f32 v113, v113
    v_mfma_f32_32x32x16_bf16 v[76:91], v[40:43], v[56:59], v[76:91]
    s_not_b64 exec, s[70:71]
    ds_read_b128 v[36:39], v7 offset:62400
    ds_read_b128 v[40:43], v8 offset:62400
    s_mov_b64 exec, -1
    v_exp_f32 v114, v114
    v_cvt_pk_bf16_f32 v54, v112, v113
    v_exp_f32 v115, v115
    v_exp_f32 v116, v116
    v_cvt_pk_bf16_f32 v55, v114, v115
    v_exp_f32 v117, v117
    v_exp_f32 v118, v118
    v_exp_f32 v119, v119
    v_mfma_f32_32x32x16_bf16 v[76:91], v[44:47], v[52:55], v[76:91]
    v_cvt_pk_bf16_f32 v56, v116, v117
    v_exp_f32 v120, v120
    v_cvt_pk_bf16_f32 v57, v118, v119
    v_exp_f32 v121, v121
    v_exp_f32 v122, v122
    v_cvt_pk_bf16_f32 v58, v120, v121
    v_exp_f32 v123, v123
    s_cmp_lt_u32 s28, 4
    s_cbranch_scc1 L_pr43
    s_setprio 2
L_pr43:
    v_exp_f32 v92, v92
    v_cvt_pk_bf16_f32 v59, v122, v123
    s_waitcnt lgkmcnt(0)
    v_mfma_f32_32x32x16_bf16 v[108:123], v[32:35], v[24:27], 0
    ds_read_b128 v[28:31], v4 offset:63488
    v_exp_f32 v93, v93
    v_exp_f32 v94, v94
    v_cvt_pk_bf16_f32 v52, v92, v93
    s_add_u32 s29, s87, 1060864
    buffer_load_dwordx4 v[140:143], v14, s[44:47], s29 offen sc1
    v_exp_f32 v95, v95
    v_exp_f32 v96, v96
    v_cvt_pk_bf16_f32 v53, v94, v95
    v_exp_f32 v97, v97
    v_mfma_f32_32x32x16_bf16 v[76:91], v[48:51], v[56:59], v[76:91]
    s_not_b64 exec, s[70:71]
    ds_read_b128 v[44:47], v7 offset:63440
    ds_read_b128 v[48:51], v8 offset:63440
    s_mov_b64 exec, -1
    v_exp_f32 v98, v98
    v_cvt_pk_bf16_f32 v54, v96, v97
    v_exp_f32 v99, v99
    v_exp_f32 v100, v100
    v_cvt_pk_bf16_f32 v55, v98, v99
    v_exp_f32 v101, v101
    v_exp_f32 v102, v102
    v_exp_f32 v103, v103
    v_mfma_f32_32x32x16_bf16 v[76:91], v[36:39], v[52:55], v[76:91]
    v_cvt_pk_bf16_f32 v56, v100, v101
    v_exp_f32 v104, v104
    v_cvt_pk_bf16_f32 v57, v102, v103
    v_exp_f32 v105, v105
    v_exp_f32 v106, v106
    v_cvt_pk_bf16_f32 v58, v104, v105
    v_exp_f32 v107, v107
    s_cmp_lt_u32 s28, 4
    s_cbranch_scc0 L_pr44
    s_setprio 1
L_pr44:
    v_exp_f32 v108, v108
    v_cvt_pk_bf16_f32 v59, v106, v107
    s_waitcnt lgkmcnt(0)
    v_mfma_f32_32x32x16_bf16 v[92:107], v[28:31], v[24:27], 0
    ds_read_b128 v[32:35], v4 offset:64512
    v_exp_f32 v109, v109
    v_exp_f32 v110, v110
    v_cvt_pk_bf16_f32 v52, v108, v109
    v_exp_f32 v111, v111
    v_exp_f32 v112, v112
    v_cvt_pk_bf16_f32 v53, v110, v111
    v_exp_f32 v113, v113
    v_mfma_f32_32x32x16_bf16 v[76:91], v[40:43], v[56:59], v[76:91]
    s_not_b64 exec, s[70:71]
    ds_read_b128 v[36:39], v7 offset:64480
    ds_read_b128 v[40:43], v8 offset:64480
    s_mov_b64 exec, -1
    v_exp_f32 v114, v114
    v_cvt_pk_bf16_f32 v54, v112, v113
    v_exp_f32 v115, v115
    v_exp_f32 v116, v116
    v_cvt_pk_bf16_f32 v55, v114, v115
    v_exp_f32 v117, v117
    v_exp_f32 v118, v118
    v_exp_f32 v119, v119
    v_mfma_f32_32x32x16_bf16 v[76:91], v[44:47], v[52:55], v[76:91]
    v_and_b32 v22, 12, v5
    v_lshlrev_b32 v22, 6, v22
    v_cvt_pk_bf16_f32 v56, v116, v117
    v_exp_f32 v120, v120
    v_cvt_pk_bf16_f32 v57, v118, v119
    v_exp_f32 v121, v121
    v_exp_f32 v122, v122
    v_cvt_pk_bf16_f32 v58, v120, v121
    v_exp_f32 v123, v123
    s_cmp_lt_u32 s28, 4
    s_cbranch_scc1 L_pr45
    s_setprio 1
L_pr45:
    v_exp_f32 v92, v92
    v_cvt_pk_bf16_f32 v59, v122, v123
    s_waitcnt lgkmcnt(0)
    v_mfma_f32_32x32x16_bf16 v[108:123], v[32:35], v[24:27], 0
    v_exp_f32 v93, v93
    v_exp_f32 v94, v94
    v_cvt_pk_bf16_f32 v52, v92, v93
    buffer_load_dword v16, v22, s[44:47], s95 offen sc1
    v_exp_f32 v95, v95
    v_exp_f32 v96, v96
    v_cvt_pk_bf16_f32 v53, v94, v95
    v_exp_f32 v97, v97
    v_mfma_f32_32x32x16_bf16 v[76:91], v[48:51], v[56:59], v[76:91]
    s_not_b64 exec, s[70:71]
    ds_read_b128 v[44:47], v7 offset:65520
    ds_read_b128 v[48:51], v8 offset:65520
    s_mov_b64 exec, -1
    v_exp_f32 v98, v98
    v_cvt_pk_bf16_f32 v54, v96, v97
    v_exp_f32 v99, v99
    v_exp_f32 v100, v100
    v_cvt_pk_bf16_f32 v55, v98, v99
    v_exp_f32 v101, v101
    v_exp_f32 v102, v102
    v_exp_f32 v103, v103
    v_mfma_f32_32x32x16_bf16 v[76:91], v[36:39], v[52:55], v[76:91]
    s_mov_b64 exec, 1
    buffer_store_dword v4, off, s[44:47], s101 sc1
    s_mov_b64 exec, -1
    v_cvt_pk_bf16_f32 v56, v100, v101
    v_exp_f32 v104, v104
    v_cvt_pk_bf16_f32 v57, v102, v103
    v_exp_f32 v105, v105
    v_exp_f32 v106, v106
    v_cvt_pk_bf16_f32 v58, v104, v105
    v_exp_f32 v107, v107
    s_cmp_lt_u32 s28, 4
    s_cbranch_scc0 L_pr46
    s_setprio 0
L_pr46:
    v_exp_f32 v108, v108
    v_cvt_pk_bf16_f32 v59, v106, v107
    s_waitcnt lgkmcnt(0)
    v_exp_f32 v109, v109
    v_exp_f32 v110, v110
    v_cvt_pk_bf16_f32 v52, v108, v109
    v_exp_f32 v111, v111
    v_exp_f32 v112, v112
    v_cvt_pk_bf16_f32 v53, v110, v111
    v_exp_f32 v113, v113
    v_mfma_f32_32x32x16_bf16 v[76:91], v[40:43], v[56:59], v[76:91]
    v_exp_f32 v114, v114
    v_cvt_pk_bf16_f32 v54, v112, v113
    v_exp_f32 v115, v115
    v_exp_f32 v116, v116
    v_cvt_pk_bf16_f32 v55, v114, v115
    v_exp_f32 v117, v117
    v_exp_f32 v118, v118
    v_exp_f32 v119, v119
    v_mfma_f32_32x32x16_bf16 v[76:91], v[44:47], v[52:55], v[76:91]
    v_cvt_pk_bf16_f32 v56, v116, v117
    v_exp_f32 v120, v120
    v_cvt_pk_bf16_f32 v57, v118, v119
    v_exp_f32 v121, v121
    v_exp_f32 v122, v122
    v_cvt_pk_bf16_f32 v58, v120, v121
    v_exp_f32 v123, v123
    s_nop 0
    v_cvt_pk_bf16_f32 v59, v122, v123
    s_and_b32 s10, s28, 3
    s_lshl_b32 s10, s10, 12
    v_mfma_f32_32x32x16_bf16 v[76:91], v[48:51], v[56:59], v[76:91]
    s_waitcnt lgkmcnt(0)
    s_nop 0
    s_add_u32 s86, s86, 65536
    s_add_u32 s81, s86, 4096
    v_add_u32 v15, s10, v18
    s_lshl_b32 s10, s26, 15
    s_lshl_b32 s3, s27, 8
    s_add_u32 s10, s10, s3
    s_mov_b32 s65, 400000
    s_mov_b32 s11, s10
    s_mov_b32 s3, 1040187392
    s_nop 1
    v_subrev_u32 v2, 0x21800000, v84
    v_cmp_gt_u32 vcc, s3, v2
    s_cmp_eq_u64 vcc, -1
    s_cbranch_scc0 L_fallback
L_fb_done:
    v_rcp_f32 v2, v84
    s_nop 0
    v_pk_mul_f32 v[76:77], v[76:77], v[2:3] op_sel:[0,0] op_sel_hi:[1,0]
    v_pk_mul_f32 v[78:79], v[78:79], v[2:3] op_sel:[0,0] op_sel_hi:[1,0]
    v_pk_mul_f32 v[80:81], v[80:81], v[2:3] op_sel:[0,0] op_sel_hi:[1,0]
    v_pk_mul_f32 v[82:83], v[82:83], v[2:3] op_sel:[0,0] op_sel_hi:[1,0]
    v_cvt_pk_bf16_f32 v76, v76, v77
    v_cvt_pk_bf16_f32 v77, v78, v79
    v_cvt_pk_bf16_f32 v78, v80, v81
    v_cvt_pk_bf16_f32 v79, v82, v83
    v_min_u32 v76, -2, v76
    v_min_u32 v77, -2, v77
    v_min_u32 v78, -2, v78
    v_min_u32 v79, -2, v79
    buffer_store_dwordx4 v[76:79], v14, s[44:47], s90 offen sc1
    s_waitcnt vmcnt(2)
    v_cmp_ne_u32 vcc, -1, v16
    s_and_b32 s99, vcc_lo, 15
    s_cmp_eq_u32 s99, 15
    s_cselect_b32 s99, 15, 0
    s_bitcmp1_b32 s99, 0
    s_cbranch_scc0 L_r1_0
    buffer_load_dwordx4 v[108:111], v17, s[44:47], s86 offen offset:0 sc1
L_r1_0:
    s_bitcmp1_b32 s99, 1
    s_cbranch_scc0 L_r1_1
    buffer_load_dwordx4 v[112:115], v17, s[44:47], s86 offen offset:2048 sc1
L_r1_1:
    s_bitcmp1_b32 s99, 2
    s_cbranch_scc0 L_r1_2
    buffer_load_dwordx4 v[116:119], v17, s[44:47], s81 offen offset:0 sc1
L_r1_2:
    s_bitcmp1_b32 s99, 3
    s_cbranch_scc0 L_r1_3
    buffer_load_dwordx4 v[120:123], v17, s[44:47], s81 offen offset:2048 sc1
L_r1_3:
    buffer_load_dword v16, v22, s[44:47], s95 offen sc1
    s_mov_b32 s100, 0
    ds_read_b128 v[28:31], v6 offset:0
    ds_read_b128 v[32:35], v6 offset:1024
    ds_read_b128 v[36:39], v6 offset:2048
    ds_read_b128 v[40:43], v6 offset:3072
    ds_read_b128 v[44:47], v6 offset:4096
    ds_read_b128 v[48:51], v6 offset:5120
    ds_read_b128 v[52:55], v6 offset:6144
    ds_read_b128 v[56:59], v6 offset:7168
    s_waitcnt lgkmcnt(7)
    v_mfma_f32_32x32x16_bf16 v[192:207], v[208:211], v[28:31], v[192:207]
    ds_read_b128 v[28:31], v6 offset:8192
    s_waitcnt lgkmcnt(7)
    v_mfma_f32_32x32x16_bf16 v[192:207], v[212:215], v[32:35], v[192:207]
    ds_read_b128 v[32:35], v6 offset:9216
    s_waitcnt lgkmcnt(7)
    v_mfma_f32_32x32x16_bf16 v[192:207], v[216:219], v[36:39], v[192:207]
    ds_read_b128 v[36:39], v6 offset:10240
    s_waitcnt lgkmcnt(7)
    v_mfma_f32_32x32x16_bf16 v[192:207], v[220:223], v[40:43], v[192:207]
    ds_read_b128 v[40:43], v6 offset:11264
    s_waitcnt lgkmcnt(7)
    v_mfma_f32_32x32x16_bf16 v[192:207], v[224:227], v[44:47], v[192:207]
    s_waitcnt lgkmcnt(6)
    v_mfma_f32_32x32x16_bf16 v[192:207], v[228:231], v[48:51], v[192:207]
    s_waitcnt lgkmcnt(5)
    v_mfma_f32_32x32x16_bf16 v[192:207], v[232:235], v[52:55], v[192:207]
    s_waitcnt lgkmcnt(4)
    v_mfma_f32_32x32x16_bf16 v[192:207], v[236:239], v[56:59], v[192:207]
    s_waitcnt lgkmcnt(3)
    v_mfma_f32_32x32x16_bf16 v[192:207], v[240:243], v[28:31], v[192:207]
    s_waitcnt lgkmcnt(2)
    v_mfma_f32_32x32x16_bf16 v[192:207], v[244:247], v[32:35], v[192:207]
    s_waitcnt lgkmcnt(1)
    v_mfma_f32_32x32x16_bf16 v[192:207], v[248:251], v[36:39], v[192:207]
    s_waitcnt lgkmcnt(0)
    v_mfma_f32_32x32x16_bf16 v[192:207], v[252:255], v[40:43], v[192:207]
    s_lshr_b32 s3, s28, 2
    s_lshl_b32 s3, s3, 4
    s_add_u32 s3, s3, 148480
    v_and_b32 v10, 12, v5
    v_add_u32 v10, s3, v10
    s_mov_b32 s12, 15
    s_lshl_b32 s3, s28, 2
    s_add_u32 s3, s3, 148480
    v_mov_b32 v12, s3
    v_mov_b32 v13, 1
    s_mov_b32 s13, 15
    s_mov_b32 s14, 0
    v_pk_mul_f32 v[192:193], v[192:193], v[20:21] op_sel:[0,0] op_sel_hi:[1,0]
    v_pk_mul_f32 v[194:195], v[194:195], v[20:21] op_sel:[0,0] op_sel_hi:[1,0]
    v_pk_mul_f32 v[196:197], v[196:197], v[20:21] op_sel:[0,0] op_sel_hi:[1,0]
    v_pk_mul_f32 v[198:199], v[198:199], v[20:21] op_sel:[0,0] op_sel_hi:[1,0]
    v_pk_mul_f32 v[200:201], v[200:201], v[20:21] op_sel:[0,0] op_sel_hi:[1,0]
    v_pk_mul_f32 v[202:203], v[202:203], v[20:21] op_sel:[0,0] op_sel_hi:[1,0]
    v_pk_mul_f32 v[204:205], v[204:205], v[20:21] op_sel:[0,0] op_sel_hi:[1,0]
    v_pk_mul_f32 v[206:207], v[206:207], v[20:21] op_sel:[0,0] op_sel_hi:[1,0]
    s_mov_b32 s15, s99
    s_waitcnt vmcnt(1)
    s_bitcmp1_b32 s15, 0
    s_cbranch_scc0 L_e_k0
    v_max3_u32 v2, v108, v109, v110
    v_max_u32 v2, v2, v111
    v_cmp_eq_u32 vcc, -1, v2
    s_cmp_eq_u64 vcc, 0
    s_cbranch_scc0 L_e_k0
    ds_write_b128 v15, v[108:111] offset:0
    s_bitset0_b32 s13, 0
L_e_k0:
    s_bitcmp1_b32 s15, 1
    s_cbranch_scc0 L_e_k1
    v_max3_u32 v2, v112, v113, v114
    v_max_u32 v2, v2, v115
    v_cmp_eq_u32 vcc, -1, v2
    s_cmp_eq_u64 vcc, 0
    s_cbranch_scc0 L_e_k1
    ds_write_b128 v15, v[112:115] offset:1024
    s_bitset0_b32 s13, 1
L_e_k1:
    s_bitcmp1_b32 s15, 2
    s_cbranch_scc0 L_e_k2
    v_max3_u32 v2, v116, v117, v118
    v_max_u32 v2, v2, v119
    v_cmp_eq_u32 vcc, -1, v2
    s_cmp_eq_u64 vcc, 0
    s_cbranch_scc0 L_e_k2
    ds_write_b128 v15, v[116:119] offset:2048
    s_bitset0_b32 s13, 2
L_e_k2:
    s_bitcmp1_b32 s15, 3
    s_cbranch_scc0 L_e_k3
    v_max3_u32 v2, v120, v121, v122
    v_max_u32 v2, v2, v123
    v_cmp_eq_u32 vcc, -1, v2
    s_cmp_eq_u64 vcc, 0
    s_cbranch_scc0 L_e_k3
    ds_write_b128 v15, v[120:123] offset:3072
    s_bitset0_b32 s13, 3
L_e_k3:
    s_or_b32 s15, s99, s100
    s_and_b32 s15, s15, s13
    s_cmp_eq_u32 s13, 0
    s_cbranch_scc1 L_t_p
L_t:
    ds_read_b32 v11, v10
    s_waitcnt lgkmcnt(0)
    v_cmp_ne_u32 vcc, 0, v11
    s_and_b32 s10, vcc_lo, s12
    s_cbranch_scc0 L_t_c
    s_andn2_b32 s12, s12, s10
    s_bitcmp1_b32 s10, 0
    s_cbranch_scc0 L_t_g0
    ds_read_b128 v[92:95], v18 offset:0
    ds_read_b128 v[96:99], v18 offset:1024
    ds_read_b128 v[100:103], v18 offset:2048
    ds_read_b128 v[104:107], v18 offset:3072
    s_waitcnt lgkmcnt(3)
    v_mfma_f32_32x32x16_bf16 v[76:91], v[128:131], v[92:95], 0
    s_waitcnt lgkmcnt(2)
    v_mfma_f32_32x32x16_bf16 v[76:91], v[132:135], v[96:99], v[76:91]
    s_waitcnt lgkmcnt(1)
    v_mfma_f32_32x32x16_bf16 v[76:91], v[136:139], v[100:103], v[76:91]
    s_waitcnt lgkmcnt(0)
    v_mfma_f32_32x32x16_bf16 v[76:91], v[140:143], v[104:107], v[76:91]
L_t_g0:
    s_bitcmp1_b32 s10, 1
    s_cbranch_scc0 L_t_g1
    ds_read_b128 v[92:95], v18 offset:4096
    ds_read_b128 v[96:99], v18 offset:5120
    ds_read_b128 v[100:103], v18 offset:6144
    ds_read_b128 v[104:107], v18 offset:7168
    s_waitcnt lgkmcnt(3)
    v_mfma_f32_32x32x16_bf16 v[60:75], v[144:147], v[92:95], 0
    s_waitcnt lgkmcnt(2)
    v_mfma_f32_32x32x16_bf16 v[60:75], v[148:151], v[96:99], v[60:75]
    s_waitcnt lgkmcnt(1)
    v_mfma_f32_32x32x16_bf16 v[60:75], v[152:155], v[100:103], v[60:75]
    s_waitcnt lgkmcnt(0)
    v_mfma_f32_32x32x16_bf16 v[60:75], v[156:159], v[104:107], v[60:75]
L_t_g1:
    s_bitcmp1_b32 s10, 2
    s_cbranch_scc0 L_t_g2
    ds_read_b128 v[92:95], v18 offset:8192
    ds_read_b128 v[96:99], v18 offset:9216
    ds_read_b128 v[100:103], v18 offset:10240
    ds_read_b128 v[104:107], v18 offset:11264
    s_waitcnt lgkmcnt(3)
    v_mfma_f32_32x32x16_bf16 v[28:43], v[160:163], v[92:95], 0
    s_waitcnt lgkmcnt(2)
    v_mfma_f32_32x32x16_bf16 v[28:43], v[164:167], v[96:99], v[28:43]
    s_waitcnt lgkmcnt(1)
    v_mfma_f32_32x32x16_bf16 v[28:43], v[168:171], v[100:103], v[28:43]
    s_waitcnt lgkmcnt(0)
    v_mfma_f32_32x32x16_bf16 v[28:43], v[172:175], v[104:107], v[28:43]
L_t_g2:
    s_bitcmp1_b32 s10, 3
    s_cbranch_scc0 L_t_g3
    ds_read_b128 v[92:95], v18 offset:12288
    ds_read_b128 v[96:99], v18 offset:13312
    ds_read_b128 v[100:103], v18 offset:14336
    ds_read_b128 v[104:107], v18 offset:15360
    s_waitcnt lgkmcnt(3)
    v_mfma_f32_32x32x16_bf16 v[44:59], v[176:179], v[92:95], 0
    s_waitcnt lgkmcnt(2)
    v_mfma_f32_32x32x16_bf16 v[44:59], v[180:183], v[96:99], v[44:59]
    s_waitcnt lgkmcnt(1)
    v_mfma_f32_32x32x16_bf16 v[44:59], v[184:187], v[100:103], v[44:59]
    s_waitcnt lgkmcnt(0)
    v_mfma_f32_32x32x16_bf16 v[44:59], v[188:191], v[104:107], v[44:59]
L_t_g3:
L_t_c:
    s_cmp_eq_u32 s13, 0
    s_cbranch_scc1 L_t_end
    s_waitcnt vmcnt(0)
    s_bitcmp1_b32 s15, 0
    s_cbranch_scc0 L_t_k0
    v_max3_u32 v2, v108, v109, v110
    v_max_u32 v2, v2, v111
    v_cmp_eq_u32 vcc, -1, v2
    s_cmp_eq_u64 vcc, 0
    s_cbranch_scc0 L_t_k0
    ds_write_b128 v15, v[108:111] offset:0
    s_bitset0_b32 s13, 0
L_t_k0:
    s_bitcmp1_b32 s15, 1
    s_cbranch_scc0 L_t_k1
    v_max3_u32 v2, v112, v113, v114
    v_max_u32 v2, v2, v115
    v_cmp_eq_u32 vcc, -1, v2
    s_cmp_eq_u64 vcc, 0
    s_cbranch_scc0 L_t_k1
    ds_write_b128 v15, v[112:115] offset:1024
    s_bitset0_b32 s13, 1
L_t_k1:
    s_bitcmp1_b32 s15, 2
    s_cbranch_scc0 L_t_k2
    v_max3_u32 v2, v116, v117, v118
    v_max_u32 v2, v2, v119
    v_cmp_eq_u32 vcc, -1, v2
    s_cmp_eq_u64 vcc, 0
    s_cbranch_scc0 L_t_k2
    ds_write_b128 v15, v[116:119] offset:2048
    s_bitset0_b32 s13, 2
L_t_k2:
    s_bitcmp1_b32 s15, 3
    s_cbranch_scc0 L_t_k3
    v_max3_u32 v2, v120, v121, v122
    v_max_u32 v2, v2, v123
    v_cmp_eq_u32 vcc, -1, v2
    s_cmp_eq_u64 vcc, 0
    s_cbranch_scc0 L_t_k3
    ds_write_b128 v15, v[120:123] offset:3072
    s_bitset0_b32 s13, 3
L_t_k3:
    s_sub_u32 s65, s65, 1
    s_cselect_b32 s13, 0, s13
    s_cmp_eq_u32 s13, 0
    s_cbranch_scc0 L_t_r
L_t_p:
    s_mov_b64 exec, 1
    ds_write_b32 v12, v13
    s_mov_b64 exec, -1
    s_branch L_t
L_t_r:
    v_cmp_eq_u32 vcc, -1, v16
    s_and_b32 s10, vcc_lo, s13
    s_mov_b32 s15, s13
    s_bcnt1_i32_b32 s3, s10
    s_cmp_le_u32 s3, 0
    s_cbranch_scc1 L_t_i
    s_mov_b32 s15, 0
    buffer_load_dword v16, v22, s[44:47], s95 offen sc1
    s_branch L_t
L_t_i:
    s_bitcmp1_b32 s15, 0
    s_cbranch_scc0 L_t_l0
    buffer_load_dwordx4 v[108:111], v17, s[44:47], s86 offen offset:0 sc1
L_t_l0:
    s_bitcmp1_b32 s15, 1
    s_cbranch_scc0 L_t_l1
    buffer_load_dwordx4 v[112:115], v17, s[44:47], s86 offen offset:2048 sc1
L_t_l1:
    s_bitcmp1_b32 s15, 2
    s_cbranch_scc0 L_t_l2
    buffer_load_dwordx4 v[116:119], v17, s[44:47], s81 offen offset:0 sc1
L_t_l2:
    s_bitcmp1_b32 s15, 3
    s_cbranch_scc0 L_t_l3
    buffer_load_dwordx4 v[120:123], v17, s[44:47], s81 offen offset:2048 sc1
L_t_l3:
    s_branch L_t
L_t_end:
    s_cmp_lg_u32 s12, 0
    s_cbranch_scc1 L_t
    s_nop 11
    v_pk_add_f32 v[76:77], v[76:77], v[60:61]
    v_pk_add_f32 v[78:79], v[78:79], v[62:63]
    v_pk_add_f32 v[80:81], v[80:81], v[64:65]
    v_pk_add_f32 v[82:83], v[82:83], v[66:67]
    v_pk_add_f32 v[84:85], v[84:85], v[68:69]
    v_pk_add_f32 v[86:87], v[86:87], v[70:71]
    v_pk_add_f32 v[88:89], v[88:89], v[72:73]
    v_pk_add_f32 v[90:91], v[90:91], v[74:75]
    v_pk_add_f32 v[28:29], v[28:29], v[44:45]
    v_pk_add_f32 v[30:31], v[30:31], v[46:47]
    v_pk_add_f32 v[32:33], v[32:33], v[48:49]
    v_pk_add_f32 v[34:35], v[34:35], v[50:51]
    v_pk_add_f32 v[36:37], v[36:37], v[52:53]
    v_pk_add_f32 v[38:39], v[38:39], v[54:55]
    v_pk_add_f32 v[40:41], v[40:41], v[56:57]
    v_pk_add_f32 v[42:43], v[42:43], v[58:59]
    v_pk_add_f32 v[76:77], v[76:77], v[28:29]
    v_pk_add_f32 v[78:79], v[78:79], v[30:31]
    v_pk_add_f32 v[80:81], v[80:81], v[32:33]
    v_pk_add_f32 v[82:83], v[82:83], v[34:35]
    v_pk_add_f32 v[84:85], v[84:85], v[36:37]
    v_pk_add_f32 v[86:87], v[86:87], v[38:39]
    v_pk_add_f32 v[88:89], v[88:89], v[40:41]
    v_pk_add_f32 v[90:91], v[90:91], v[42:43]
    v_pk_fma_f32 v[76:77], v[76:77], v[20:21], v[192:193] op_sel:[0,1,0] op_sel_hi:[1,1,1]
    v_pk_fma_f32 v[78:79], v[78:79], v[20:21], v[194:195] op_sel:[0,1,0] op_sel_hi:[1,1,1]
    v_pk_fma_f32 v[80:81], v[80:81], v[20:21], v[196:197] op_sel:[0,1,0] op_sel_hi:[1,1,1]
    v_pk_fma_f32 v[82:83], v[82:83], v[20:21], v[198:199] op_sel:[0,1,0] op_sel_hi:[1,1,1]
    v_pk_fma_f32 v[84:85], v[84:85], v[20:21], v[200:201] op_sel:[0,1,0] op_sel_hi:[1,1,1]
    v_pk_fma_f32 v[86:87], v[86:87], v[20:21], v[202:203] op_sel:[0,1,0] op_sel_hi:[1,1,1]
    v_pk_fma_f32 v[88:89], v[88:89], v[20:21], v[204:205] op_sel:[0,1,0] op_sel_hi:[1,1,1]
    v_pk_fma_f32 v[90:91], v[90:91], v[20:21], v[206:207] op_sel:[0,1,0] op_sel_hi:[1,1,1]
    ds_write_b128 v19, v[76:79] offset:0
    ds_write_b128 v19, v[80:83] offset:32
    ds_write_b128 v19, v[84:87] offset:64
    ds_write_b128 v19, v[88:91] offset:96
    s_waitcnt lgkmcnt(0)
    s_barrier
    ds_read_b128 v[92:95], v23
    ds_read_b128 v[96:99], v23 offset:16
    ds_read_b128 v[100:103], v23 offset:16896
    ds_read_b128 v[104:107], v23 offset:16912
    s_waitcnt lgkmcnt(0)
    v_add_f32 v92, v92, v100
    v_add_f32 v93, v93, v101
    v_add_f32 v94, v94, v102
    v_add_f32 v95, v95, v103
    v_add_f32 v96, v96, v104
    v_add_f32 v97, v97, v105
    v_add_f32 v98, v98, v106
    v_add_f32 v99, v99, v107
    v_cvt_pk_bf16_f32 v92, v92, v93
    v_cvt_pk_bf16_f32 v93, v94, v95
    v_cvt_pk_bf16_f32 v94, v96, v97
    v_cvt_pk_bf16_f32 v95, v98, v99
    buffer_store_dwordx4 v[92:95], v127, s[52:55], s11 offen sc0 nt sc1
L_end:
    s_endpgm
L_fallback:
    v_mov_b32 v2, 0xff800000
    s_lshl_b32 s30, s24, 17
    s_add_u32 s30, s30, 4194304
    s_mov_b32 s10, 0
    s_mov_b32 s12, 555159045
    s_mov_b32 s13, 87831338
L_fb_max:
    s_and_b32 s29, s10, 7
    s_lshl_b32 s29, s29, 3
    s_lshr_b64 s[14:15], s[12:13], s29
    s_and_b32 s14, s14, 0xff
    s_lshl_b32 s29, s14, 7
    s_lshl_b32 s3, s10, 11
    s_add_u32 s3, s3, s30
    v_add_u32 v3, s29, v4
    v_lshrrev_b32 v3, 10, v3
    v_lshl_add_u32 v3, v3, 7, v4
    buffer_load_dwordx4 v[28:31], v3, s[44:47], s3 offen sc1
    s_waitcnt vmcnt(0)
    v_mfma_f32_32x32x16_bf16 v[92:107], v[28:31], v[24:27], 0
    s_nop 11
    v_max3_f32 v2, v2, v92, v93
    v_max3_f32 v2, v2, v94, v95
    v_max3_f32 v2, v2, v96, v97
    v_max3_f32 v2, v2, v98, v99
    v_max3_f32 v2, v2, v100, v101
    v_max3_f32 v2, v2, v102, v103
    v_max3_f32 v2, v2, v104, v105
    v_max3_f32 v2, v2, v106, v107
    s_add_u32 s10, s10, 1
    s_cmp_lt_u32 s10, 64
    s_cbranch_scc1 L_fb_max
    v_mov_b32 v3, v2
    s_nop 1
    v_permlane32_swap_b32 v2, v3
    s_nop 1
    v_max_f32 v2, v2, v3
    v_sub_f32 v2, 0, v2
    v_subrev_u32 v3, 65536, v7
    v_mov_b32 v60, v2
    v_mov_b32 v76, 0
    v_mov_b32 v61, v2
    v_mov_b32 v77, 0
    v_mov_b32 v62, v2
    v_mov_b32 v78, 0
    v_mov_b32 v63, v2
    v_mov_b32 v79, 0
    v_mov_b32 v64, v2
    v_mov_b32 v80, 0
    v_mov_b32 v65, v2
    v_mov_b32 v81, 0
    v_mov_b32 v66, v2
    v_mov_b32 v82, 0
    v_mov_b32 v67, v2
    v_mov_b32 v83, 0
    v_mov_b32 v68, v2
    v_mov_b32 v84, 0
    v_mov_b32 v69, v2
    v_mov_b32 v85, 0
    v_mov_b32 v70, v2
    v_mov_b32 v86, 0
    v_mov_b32 v71, v2
    v_mov_b32 v87, 0
    v_mov_b32 v72, v2
    v_mov_b32 v88, 0
    v_mov_b32 v73, v2
    v_mov_b32 v89, 0
    v_mov_b32 v74, v2
    v_mov_b32 v90, 0
    v_mov_b32 v75, v2
    v_mov_b32 v91, 0
    s_mov_b32 s10, 0
    s_mov_b32 s66, 0x0000ffff
    s_mov_b32 s67, 0x0000ffff
    v_add_u32 v2, 256, v3
L_fb_loop:
    s_and_b32 s29, s10, 7
    s_lshl_b32 s29, s29, 3
    s_lshr_b64 s[14:15], s[12:13], s29
    s_and_b32 s14, s14, 0xff
    s_lshl_b32 s29, s14, 7
    s_lshl_b32 s3, s10, 11
    s_add_u32 s3, s3, s30
    v_add_u32 v52, s29, v4
    v_lshrrev_b32 v52, 10, v52
    v_lshl_add_u32 v52, v52, 7, v4
    v_add_u32 v53, s29, v3
    v_lshrrev_b32 v53, 10, v53
    v_lshl_add_u32 v53, v53, 7, v3
    v_add_u32 v54, s29, v2
    v_lshrrev_b32 v54, 10, v54
    v_lshl_add_u32 v54, v54, 7, v2
    buffer_load_dwordx4 v[28:31], v52, s[44:47], s3 offen sc1
    s_add_u32 s3, s3, 4194304
    s_mov_b64 exec, s[66:67]
    buffer_load_dwordx4 v[36:39], v53, s[44:47], s3 offen sc1
    buffer_load_dwordx4 v[40:43], v54, s[44:47], s3 offen sc1
    s_mov_b64 exec, -1
    s_waitcnt vmcnt(0)
    v_mfma_f32_32x32x16_bf16 v[92:107], v[28:31], v[24:27], v[60:75]
    s_nop 11
    v_exp_f32 v92, v92
    v_exp_f32 v93, v93
    v_exp_f32 v94, v94
    v_exp_f32 v95, v95
    v_exp_f32 v96, v96
    v_exp_f32 v97, v97
    v_exp_f32 v98, v98
    v_exp_f32 v99, v99
    v_exp_f32 v100, v100
    v_exp_f32 v101, v101
    v_exp_f32 v102, v102
    v_exp_f32 v103, v103
    v_exp_f32 v104, v104
    v_exp_f32 v105, v105
    v_exp_f32 v106, v106
    v_exp_f32 v107, v107
    s_nop 0
    v_cvt_pk_bf16_f32 v52, v92, v93
    v_cvt_pk_bf16_f32 v53, v94, v95
    v_cvt_pk_bf16_f32 v54, v96, v97
    v_cvt_pk_bf16_f32 v55, v98, v99
    v_cvt_pk_bf16_f32 v56, v100, v101
    v_cvt_pk_bf16_f32 v57, v102, v103
    v_cvt_pk_bf16_f32 v58, v104, v105
    v_cvt_pk_bf16_f32 v59, v106, v107
    s_nop 1
    v_mfma_f32_32x32x16_bf16 v[76:91], v[36:39], v[52:55], v[76:91]
    v_mfma_f32_32x32x16_bf16 v[76:91], v[40:43], v[56:59], v[76:91]
    s_add_u32 s10, s10, 1
    s_cmp_lt_u32 s10, 64
    s_cbranch_scc1 L_fb_loop
    s_nop 11
    s_branch L_fb_done
L_fa:
    v_mfma_f32_32x32x16_bf16 v[224:239], v[166:169], v[244:247], v[176:191]
    v_mfma_f32_32x32x16_bf16 v[128:143], v[248:251], v[244:247], v[192:207]
    s_nop 15
    v_max3_f32 v15, v224, v225, v226
    v_max3_f32 v15, v15, v227, v228
    v_max3_f32 v15, v15, v229, v230
    v_max3_f32 v15, v15, v231, v232
    v_max3_f32 v15, v15, v233, v234
    v_max3_f32 v15, v15, v235, v236
    v_max3_f32 v15, v15, v237, v238
    v_max_f32 v15, v15, v239
    v_max3_f32 v15, v15, v136, v137
    v_max3_f32 v15, v15, v138, v139
    v_max3_f32 v15, v15, v140, v141
    v_max3_f32 v15, v15, v142, v143
    v_mov_b32 v16, v15
    s_nop 1
    v_permlane32_swap_b32 v15, v16
    s_nop 1
    v_max_f32 v15, v15, v16
    v_sub_f32 v224, v224, v15
    v_sub_f32 v225, v225, v15
    v_sub_f32 v226, v226, v15
    v_sub_f32 v227, v227, v15
    v_sub_f32 v228, v228, v15
    v_sub_f32 v229, v229, v15
    v_sub_f32 v230, v230, v15
    v_sub_f32 v231, v231, v15
    v_sub_f32 v232, v232, v15
    v_sub_f32 v233, v233, v15
    v_sub_f32 v234, v234, v15
    v_sub_f32 v235, v235, v15
    v_sub_f32 v236, v236, v15
    v_sub_f32 v237, v237, v15
    v_sub_f32 v238, v238, v15
    v_sub_f32 v239, v239, v15
    v_sub_f32 v136, v136, v15
    v_sub_f32 v137, v137, v15
    v_sub_f32 v138, v138, v15
    v_sub_f32 v139, v139, v15
    v_sub_f32 v140, v140, v15
    v_sub_f32 v141, v141, v15
    v_sub_f32 v142, v142, v15
    v_sub_f32 v143, v143, v15
    v_exp_f32 v224, v224
    v_exp_f32 v225, v225
    v_exp_f32 v226, v226
    v_exp_f32 v227, v227
    v_exp_f32 v228, v228
    v_exp_f32 v229, v229
    v_exp_f32 v230, v230
    v_exp_f32 v231, v231
    v_exp_f32 v232, v232
    v_exp_f32 v233, v233
    v_exp_f32 v234, v234
    v_exp_f32 v235, v235
    v_exp_f32 v236, v236
    v_exp_f32 v237, v237
    v_exp_f32 v238, v238
    v_exp_f32 v239, v239
    v_exp_f32 v136, v136
    v_exp_f32 v137, v137
    v_exp_f32 v138, v138
    v_exp_f32 v139, v139
    v_exp_f32 v140, v140
    v_exp_f32 v141, v141
    v_exp_f32 v142, v142
    v_exp_f32 v143, v143
    s_nop 0
    v_cvt_pk_bf16_f32 v224, v224, v225
    v_cvt_pk_bf16_f32 v225, v226, v227
    v_cvt_pk_bf16_f32 v226, v228, v229
    v_cvt_pk_bf16_f32 v227, v230, v231
    v_cvt_pk_bf16_f32 v228, v232, v233
    v_cvt_pk_bf16_f32 v229, v234, v235
    v_cvt_pk_bf16_f32 v230, v236, v237
    v_cvt_pk_bf16_f32 v231, v238, v239
    v_cvt_pk_bf16_f32 v136, v136, v137
    v_cvt_pk_bf16_f32 v137, v138, v139
    v_cvt_pk_bf16_f32 v138, v140, v141
    v_cvt_pk_bf16_f32 v139, v142, v143
    s_nop 1
    v_mfma_f32_32x32x16_bf16 v[208:223], v[240:243], v[224:227], 0
    v_mfma_f32_32x32x16_bf16 v[208:223], v[172:175], v[228:231], v[208:223]
    v_mfma_f32_32x32x16_bf16 v[208:223], v[252:255], v[136:139], v[208:223]
    s_nop 15
    s_branch L_fa_done
L_code_end:
.section .rodata,"a"
.p2align 6
.amdhsa_kernel gated_mix__sliding_local_dilated__softmax_full_mha__prompt_kernel
  .amdhsa_next_free_vgpr 256
  .amdhsa_next_free_sgpr 102
  .amdhsa_accum_offset 256
  .amdhsa_group_segment_fixed_size 0
  .amdhsa_kernarg_size 80
  .amdhsa_user_sgpr_count 2
  .amdhsa_user_sgpr_kernarg_segment_ptr 1
  .amdhsa_system_sgpr_workgroup_id_x 1
.end_amdhsa_kernel
```
